```python
import torch

def _softmax(x, axis=-1):
    return torch.softmax(x, dim=axis)
def _gelu(x):
    return torch.nn.functional.gelu(x, approximate="tanh")
def _silu(x):
    return torch.nn.functional.silu(x)
def _sigmoid(x):
    return torch.sigmoid(x)
def _layernorm(x, axis=-1, eps=1e-5):
    m = x.mean(dim=axis, keepdim=True)
    v = x.var(dim=axis, keepdim=True, unbiased=False)
    return (x - m) / torch.sqrt(v + eps)
def _scatter_add(tgt, idx, src, axis=0):
    return tgt.clone().index_add_(axis, idx, src)
def _segment_sum(src, seg, n):
    out = torch.zeros((n,) + src.shape[1:], dtype=src.dtype)
    return out.index_add_(0, seg, src)
def _pad(x, pw):
    flat = tuple(v for pair in reversed(pw) for v in pair)
    return torch.nn.functional.pad(x, flat)

kernel_name = 'sequential_preLN__linear_kernel_hedgehog__dense_activation_relu__prompt'

def setup_inputs():

    _w = (lambda a: (lambda t: t.to(torch.bfloat16) if t.is_floating_point() else t)(torch.as_tensor(a)))
    def _A_setup():
        B, S, D, H = 1, 2048, 1024, 32
        Dh = D // H
        return {
            "x": _w((lambda *s: torch.randn(*s, dtype=torch.bfloat16) * 0.05)(B, S, D)),
            "wqkv": _w((lambda *s: torch.randn(*s, dtype=torch.bfloat16) * 0.2)(D, 3 * D)),
            "w_phi": _w((lambda *s: torch.randn(*s, dtype=torch.bfloat16) * 0.2)(H, Dh, Dh) * (Dh ** -0.5)),
            "wo": _w((lambda *s: torch.randn(*s, dtype=torch.bfloat16) * 0.05)(D, D)),
        }
    _A_in = _A_setup()

    def _B_setup():
        B, S, D, Dff = 1, 2048, 1024, 3584
        return {
            "x": _w((lambda *s: torch.randn(*s, dtype=torch.bfloat16) * 0.05)(B, S, D)),
            "w1": _w((lambda *s: torch.randn(*s, dtype=torch.bfloat16) * 0.05)(D, Dff)),
            "w2": _w((lambda *s: torch.randn(*s, dtype=torch.bfloat16) * 0.05)(Dff, D)),
        }
    _B_in = _B_setup()

    return {
        "A_x": _A_in["x"],
        "A_wqkv": _A_in["wqkv"],
        "A_w_phi": _A_in["w_phi"],
        "A_wo": _A_in["wo"],
        "B_x": _B_in["x"],
        "B_w1": _B_in["w1"],
        "B_w2": _B_in["w2"],
    }

def reference(A_x, A_wqkv, A_w_phi, A_wo, B_x, B_w1, B_w2):
    def _A_ref(x, wqkv, w_phi, wo):
        B, S, D = x.shape
        H = 32; Dh = D // H
        qkv = (lambda x, *d: x.permute(*d))((x @ wqkv).reshape(B, S, 3, H, Dh), 2, 0, 3, 1, 4)
        q, k, v = qkv[0], qkv[1], qkv[2]
        pq = torch.einsum("bhsd,hdf->bhsf", q, w_phi)
        pk = torch.einsum("bhsd,hdf->bhsf", k, w_phi)
        phi_q = torch.concatenate([_softmax(pq, axis=-1), _softmax(-pq, axis=-1)], axis=-1)
        phi_k = torch.concatenate([_softmax(pk, axis=-1), _softmax(-pk, axis=-1)], axis=-1)
        kv = torch.einsum("bhsf,bhsd->bhfd", phi_k, v)
        z  = torch.einsum("bhsf->bhf", phi_k)
        num = torch.einsum("bhqf,bhfd->bhqd", phi_q, kv)
        den = torch.einsum("bhqf,bhf->bhq", phi_q, z)[..., None] + 1e-6
        o = num / den
        return (lambda x, *d: x.permute(*d))(o, 0, 2, 1, 3).reshape(B, S, D) @ wo

    def _B_ref(x, w1, w2):
        h = torch.einsum("bsd,df->bsf", x, w1)
        zero = torch.zeros_like(h)
        h = torch.maximum(h, zero)
        return torch.einsum("bsf,fd->bsd", h, w2)

    x = A_x
    h = x + _A_ref(_layernorm(x, axis=-1), A_wqkv, A_w_phi, A_wo)
    h2 = h + _B_ref(_layernorm(h, axis=-1), B_w1, B_w2)
    return h2
```

```asm
; @launch kernel=mega_kernel grid=(256,1,1) block=(512,1,1) lds=153472
.amdgcn_target "amdgcn-amd-amdhsa--gfx950"
.text
.globl mega_kernel
.p2align 8
.type mega_kernel,@function
mega_kernel:
  s_cmp_ge_u32 s2, 256
  s_cbranch_scc1 Lend_1
  s_load_dwordx2 s[4:5], s[0:1], 72
  s_load_dwordx2 s[6:7], s[0:1], 8
  s_load_dwordx2 s[8:9], s[0:1], 64
  s_load_dwordx2 s[10:11], s[0:1], 0
  s_load_dwordx2 s[14:15], s[0:1], 16
  s_load_dwordx2 s[64:65], s[0:1], 40
  s_load_dwordx2 s[66:67], s[0:1], 48
  s_load_dwordx2 s[68:69], s[0:1], 24
  v_and_b32 v144, 63, v0
  v_lshrrev_b32 v1, 6, v0
  s_nop 0
  v_readfirstlane_b32 s40, v1
  s_and_b32 s52, s2, 7
  s_lshr_b32 s53, s2, 3
  s_and_b32 s54, s52, 1
  s_lshl_b32 s41, s54, 2
  s_and_b32 s54, s53, 3
  s_add_u32 s41, s41, s54
  s_lshr_b32 s54, s52, 1
  s_lshl_b32 s42, s54, 3
  s_lshr_b32 s54, s53, 2
  s_add_u32 s42, s42, s54
  s_and_b32 s54, s53, 3
  s_lshl_b32 s54, s54, 2
  s_bfe_u32 s55, s53, 0x20002
  s_add_u32 s54, s54, s55
  s_lshl_b32 s46, s54, 7
  s_mul_i32 s47, s54, 393216
  s_mov_b32 s56, 0x3fb8aa3b
  s_mov_b32 s57, 0x3f803f80
  s_waitcnt lgkmcnt(0)
  s_lshl_b32 s52, s41, 19
  s_add_u32 s12, s10, s52
  s_addc_u32 s13, s11, 0
  s_mov_b32 s16, s12
  s_and_b32 s17, s13, 0xffff
  s_mov_b32 s18, 0x80000
  s_mov_b32 s19, 0x00020000
  s_lshl_b32 s52, s42, 6
  s_add_u32 s12, s6, s52
  s_addc_u32 s13, s7, 0
  s_sub_u32 s53, 6291456, s52
  s_mov_b32 s20, s12
  s_and_b32 s21, s13, 0xffff
  s_mov_b32 s22, s53
  s_mov_b32 s23, 0x00020000
  s_lshl_b32 s52, s42, 7
  s_mul_i32 s53, s41, 540672
  s_add_u32 s52, s52, s53
  s_add_u32 s12, s4, s52
  s_addc_u32 s13, s5, 0
  s_mov_b32 s24, s12
  s_and_b32 s25, s13, 0xffff
  s_mov_b32 s26, 0x84000
  s_mov_b32 s27, 0x00020000
  s_mul_i32 s52, s42, 69632
  s_add_u32 s52, s52, 26214400
  s_add_u32 s12, s4, s52
  s_addc_u32 s13, s5, 0
  s_mov_b32 s28, s12
  s_and_b32 s29, s13, 0xffff
  s_mov_b32 s30, 0x11000
  s_mov_b32 s31, 0x00020000
  s_cmp_lt_u32 s40, 4
  s_cbranch_scc1 Lconsumer_3
  s_sub_u32 s43, s40, 4
  s_lshl_b32 s52, s41, 8
  s_lshl_b32 s53, s42, 3
  s_add_u32 s52, s52, s53
  s_lshl_b32 s53, s43, 1
  s_add_u32 s74, s52, s53
  s_lshl_b32 s53, s74, 11
  v_lshlrev_b32 v145, 4, v144
  v_add_u32 v145, s53, v145
  global_load_dwordx4 v[64:67], v145, s[10:11]
  global_load_dwordx4 v[68:71], v145, s[10:11] offset:1024
  global_load_dwordx4 v[72:75], v145, s[10:11] offset:2048
  global_load_dwordx4 v[76:79], v145, s[10:11] offset:3072
  v_lshrrev_b32 v145, 3, v144
  v_and_b32 v146, 7, v144
  s_mul_i32 s52, s43, 64
  v_add_u32 v147, s52, v145
  v_bfe_u32 v148, v147, 1, 3
  v_xor_b32 v148, v148, v146
  v_lshlrev_b32 v148, 4, v148
  s_mov_b32 s53, 2048
  v_mul_lo_u32 v147, v147, s53
  v_add_u32 v32, v147, v148
  v_add_u32 v147, s52, v145
  v_add_u32 v147, 8, v147
  v_bfe_u32 v148, v147, 1, 3
  v_xor_b32 v148, v148, v146
  v_lshlrev_b32 v148, 4, v148
  s_mov_b32 s53, 2048
  v_mul_lo_u32 v147, v147, s53
  v_add_u32 v33, v147, v148
  v_add_u32 v147, s52, v145
  v_add_u32 v147, 16, v147
  v_bfe_u32 v148, v147, 1, 3
  v_xor_b32 v148, v148, v146
  v_lshlrev_b32 v148, 4, v148
  s_mov_b32 s53, 2048
  v_mul_lo_u32 v147, v147, s53
  v_add_u32 v34, v147, v148
  v_add_u32 v147, s52, v145
  v_add_u32 v147, 24, v147
  v_bfe_u32 v148, v147, 1, 3
  v_xor_b32 v148, v148, v146
  v_lshlrev_b32 v148, 4, v148
  s_mov_b32 s53, 2048
  v_mul_lo_u32 v147, v147, s53
  v_add_u32 v35, v147, v148
  v_add_u32 v147, s52, v145
  v_add_u32 v147, 32, v147
  v_bfe_u32 v148, v147, 1, 3
  v_xor_b32 v148, v148, v146
  v_lshlrev_b32 v148, 4, v148
  s_mov_b32 s53, 2048
  v_mul_lo_u32 v147, v147, s53
  v_add_u32 v36, v147, v148
  v_add_u32 v147, s52, v145
  v_add_u32 v147, 40, v147
  v_bfe_u32 v148, v147, 1, 3
  v_xor_b32 v148, v148, v146
  v_lshlrev_b32 v148, 4, v148
  s_mov_b32 s53, 2048
  v_mul_lo_u32 v147, v147, s53
  v_add_u32 v37, v147, v148
  v_add_u32 v147, s52, v145
  v_add_u32 v147, 48, v147
  v_bfe_u32 v148, v147, 1, 3
  v_xor_b32 v148, v148, v146
  v_lshlrev_b32 v148, 4, v148
  s_mov_b32 s53, 2048
  v_mul_lo_u32 v147, v147, s53
  v_add_u32 v38, v147, v148
  v_add_u32 v147, s52, v145
  v_add_u32 v147, 56, v147
  v_bfe_u32 v148, v147, 1, 3
  v_xor_b32 v148, v148, v146
  v_lshlrev_b32 v148, 4, v148
  s_mov_b32 s53, 2048
  v_mul_lo_u32 v147, v147, s53
  v_add_u32 v39, v147, v148
  s_mul_i32 s52, s43, 192
  v_add_u32 v145, s52, v144
  v_mul_u32_u24 v146, 683, v145
  v_lshrrev_b32 v146, 13, v146
  v_mul_u32_u24 v147, 12, v146
  v_sub_u32 v147, v145, v147
  v_lshrrev_b32 v148, 2, v147
  v_lshlrev_b32 v148, 11, v148
  v_and_b32 v147, 3, v147
  v_lshlrev_b32 v147, 4, v147
  v_add_u32 v147, v147, v148
  s_mov_b32 s53, 6144
  v_mul_lo_u32 v146, v146, s53
  v_add_u32 v40, v146, v147
  v_add_u32 v145, s52, v144
  v_add_u32 v145, 64, v145
  v_mul_u32_u24 v146, 683, v145
  v_lshrrev_b32 v146, 13, v146
  v_mul_u32_u24 v147, 12, v146
  v_sub_u32 v147, v145, v147
  v_lshrrev_b32 v148, 2, v147
  v_lshlrev_b32 v148, 11, v148
  v_and_b32 v147, 3, v147
  v_lshlrev_b32 v147, 4, v147
  v_add_u32 v147, v147, v148
  s_mov_b32 s53, 6144
  v_mul_lo_u32 v146, v146, s53
  v_add_u32 v41, v146, v147
  v_add_u32 v145, s52, v144
  v_add_u32 v145, 128, v145
  v_mul_u32_u24 v146, 683, v145
  v_lshrrev_b32 v146, 13, v146
  v_mul_u32_u24 v147, 12, v146
  v_sub_u32 v147, v145, v147
  v_lshrrev_b32 v148, 2, v147
  v_lshlrev_b32 v148, 11, v148
  v_and_b32 v147, 3, v147
  v_lshlrev_b32 v147, 4, v147
  v_add_u32 v147, v147, v148
  s_mov_b32 s53, 6144
  v_mul_lo_u32 v146, v146, s53
  v_add_u32 v42, v146, v147
  s_mov_b32 s73, 0
  s_mov_b32 s78, 0
  s_mov_b32 s79, 0
  s_mul_i32 s48, s43, 8192
  s_mul_i32 s49, s43, 3072
  s_add_u32 s49, s49, 98304
  s_mov_b32 s45, 0
  s_mov_b32 s51, 0
  s_add_u32 m0, s51, s49
  s_nop 0
  buffer_load_dwordx4 v40, s[20:23], s47 offen lds
  s_add_u32 m0, m0, 0x400
  s_nop 0
  buffer_load_dwordx4 v41, s[20:23], s47 offen lds
  s_add_u32 m0, m0, 0x400
  s_nop 0
  buffer_load_dwordx4 v42, s[20:23], s47 offen lds
  s_add_u32 s51, s51, 12288
  s_cmp_eq_u32 s51, 36864
  s_cselect_b32 s51, 0, s51
  s_add_u32 s47, s47, 393216
  s_cmp_eq_u32 s47, 6291456
  s_cselect_b32 s47, 0, s47
  s_add_u32 m0, s45, s48
  s_nop 0
  buffer_load_dwordx4 v32, s[16:19], s46 offen lds
  s_add_u32 m0, m0, 0x400
  s_nop 0
  buffer_load_dwordx4 v33, s[16:19], s46 offen lds
  s_add_u32 m0, m0, 0x400
  s_nop 0
  buffer_load_dwordx4 v34, s[16:19], s46 offen lds
  s_add_u32 m0, m0, 0x400
  s_nop 0
  buffer_load_dwordx4 v35, s[16:19], s46 offen lds
  s_add_u32 m0, m0, 0x400
  s_nop 0
  buffer_load_dwordx4 v36, s[16:19], s46 offen lds
  s_add_u32 m0, m0, 0x400
  s_nop 0
  buffer_load_dwordx4 v37, s[16:19], s46 offen lds
  s_add_u32 m0, m0, 0x400
  s_nop 0
  buffer_load_dwordx4 v38, s[16:19], s46 offen lds
  s_add_u32 m0, m0, 0x400
  s_nop 0
  buffer_load_dwordx4 v39, s[16:19], s46 offen lds
  s_add_u32 s45, s45, 32768
  s_cmp_eq_u32 s45, 98304
  s_cselect_b32 s45, 0, s45
  s_add_u32 s46, s46, 128
  s_cmp_eq_u32 s46, 2048
  s_cselect_b32 s46, 0, s46
  s_add_u32 m0, s51, s49
  s_nop 0
  buffer_load_dwordx4 v40, s[20:23], s47 offen lds
  s_add_u32 m0, m0, 0x400
  s_nop 0
  buffer_load_dwordx4 v41, s[20:23], s47 offen lds
  s_add_u32 m0, m0, 0x400
  s_nop 0
  buffer_load_dwordx4 v42, s[20:23], s47 offen lds
  s_add_u32 s51, s51, 12288
  s_cmp_eq_u32 s51, 36864
  s_cselect_b32 s51, 0, s51
  s_add_u32 s47, s47, 393216
  s_cmp_eq_u32 s47, 6291456
  s_cselect_b32 s47, 0, s47
  s_add_u32 m0, s45, s48
  s_nop 0
  buffer_load_dwordx4 v32, s[16:19], s46 offen lds
  s_add_u32 m0, m0, 0x400
  s_nop 0
  buffer_load_dwordx4 v33, s[16:19], s46 offen lds
  s_add_u32 m0, m0, 0x400
  s_nop 0
  buffer_load_dwordx4 v34, s[16:19], s46 offen lds
  s_add_u32 m0, m0, 0x400
  s_nop 0
  buffer_load_dwordx4 v35, s[16:19], s46 offen lds
  s_add_u32 m0, m0, 0x400
  s_nop 0
  buffer_load_dwordx4 v36, s[16:19], s46 offen lds
  s_add_u32 m0, m0, 0x400
  s_nop 0
  buffer_load_dwordx4 v37, s[16:19], s46 offen lds
  s_add_u32 m0, m0, 0x400
  s_nop 0
  buffer_load_dwordx4 v38, s[16:19], s46 offen lds
  s_add_u32 m0, m0, 0x400
  s_nop 0
  buffer_load_dwordx4 v39, s[16:19], s46 offen lds
  s_add_u32 s45, s45, 32768
  s_cmp_eq_u32 s45, 98304
  s_cselect_b32 s45, 0, s45
  s_add_u32 s46, s46, 128
  s_cmp_eq_u32 s46, 2048
  s_cselect_b32 s46, 0, s46
  s_mov_b32 s50, 0
Lprod_4:
  s_waitcnt vmcnt(11)
  s_barrier
  s_add_u32 m0, s51, s49
  s_nop 0
  buffer_load_dwordx4 v40, s[20:23], s47 offen lds
  s_add_u32 m0, m0, 0x400
  s_nop 0
  buffer_load_dwordx4 v41, s[20:23], s47 offen lds
  s_add_u32 m0, m0, 0x400
  s_nop 0
  buffer_load_dwordx4 v42, s[20:23], s47 offen lds
  s_add_u32 s51, s51, 12288
  s_cmp_eq_u32 s51, 36864
  s_cselect_b32 s51, 0, s51
  s_add_u32 s47, s47, 393216
  s_cmp_eq_u32 s47, 6291456
  s_cselect_b32 s47, 0, s47
  s_add_u32 m0, s45, s48
  s_nop 0
  buffer_load_dwordx4 v32, s[16:19], s46 offen lds
  s_add_u32 m0, m0, 0x400
  s_nop 0
  buffer_load_dwordx4 v33, s[16:19], s46 offen lds
  s_add_u32 m0, m0, 0x400
  s_nop 0
  buffer_load_dwordx4 v34, s[16:19], s46 offen lds
  s_add_u32 m0, m0, 0x400
  s_nop 0
  buffer_load_dwordx4 v35, s[16:19], s46 offen lds
  s_add_u32 m0, m0, 0x400
  s_nop 0
  buffer_load_dwordx4 v36, s[16:19], s46 offen lds
  s_add_u32 m0, m0, 0x400
  s_nop 0
  buffer_load_dwordx4 v37, s[16:19], s46 offen lds
  s_add_u32 m0, m0, 0x400
  s_nop 0
  buffer_load_dwordx4 v38, s[16:19], s46 offen lds
  s_add_u32 m0, m0, 0x400
  s_nop 0
  buffer_load_dwordx4 v39, s[16:19], s46 offen lds
  s_add_u32 s45, s45, 32768
  s_cmp_eq_u32 s45, 98304
  s_cselect_b32 s45, 0, s45
  s_add_u32 s46, s46, 128
  s_cmp_eq_u32 s46, 2048
  s_cselect_b32 s46, 0, s46
  s_cmp_lg_u32 s50, 0
  s_cbranch_scc1 Lhook_5
  v_lshlrev_b32 v80, 16, v64
  v_and_b32 v81, 0xffff0000, v64
  v_lshlrev_b32 v82, 16, v65
  v_and_b32 v83, 0xffff0000, v65
  v_lshlrev_b32 v84, 16, v66
  v_and_b32 v85, 0xffff0000, v66
  v_lshlrev_b32 v86, 16, v67
  v_and_b32 v87, 0xffff0000, v67
  v_lshlrev_b32 v88, 16, v68
  v_and_b32 v89, 0xffff0000, v68
  v_lshlrev_b32 v90, 16, v69
  v_and_b32 v91, 0xffff0000, v69
  v_lshlrev_b32 v92, 16, v70
  v_and_b32 v93, 0xffff0000, v70
  v_lshlrev_b32 v94, 16, v71
  v_and_b32 v95, 0xffff0000, v71
  v_lshlrev_b32 v96, 16, v72
  v_and_b32 v97, 0xffff0000, v72
  v_lshlrev_b32 v98, 16, v73
  v_and_b32 v99, 0xffff0000, v73
  v_lshlrev_b32 v100, 16, v74
  v_and_b32 v101, 0xffff0000, v74
  v_lshlrev_b32 v102, 16, v75
  v_and_b32 v103, 0xffff0000, v75
  v_lshlrev_b32 v104, 16, v76
  v_and_b32 v105, 0xffff0000, v76
  v_lshlrev_b32 v106, 16, v77
  v_and_b32 v107, 0xffff0000, v77
  v_lshlrev_b32 v108, 16, v78
  v_and_b32 v109, 0xffff0000, v78
  v_lshlrev_b32 v110, 16, v79
  v_and_b32 v111, 0xffff0000, v79
  v_add_f32 v112, v80, v81
  v_add_f32 v114, v82, v83
  v_add_f32 v113, v96, v97
  v_add_f32 v115, v98, v99
  v_add_f32 v112, v112, v84
  v_add_f32 v114, v114, v85
  v_add_f32 v113, v113, v100
  v_add_f32 v115, v115, v101
  v_add_f32 v112, v112, v86
  v_add_f32 v114, v114, v87
  v_add_f32 v113, v113, v102
  v_add_f32 v115, v115, v103
  v_add_f32 v112, v112, v88
  v_add_f32 v114, v114, v89
  v_add_f32 v113, v113, v104
  v_add_f32 v115, v115, v105
  v_add_f32 v112, v112, v90
  v_add_f32 v114, v114, v91
  v_add_f32 v113, v113, v106
  v_add_f32 v115, v115, v107
  v_add_f32 v112, v112, v92
  v_add_f32 v114, v114, v93
  v_add_f32 v113, v113, v108
  v_add_f32 v115, v115, v109
  v_add_f32 v112, v112, v94
  v_add_f32 v114, v114, v95
  v_add_f32 v113, v113, v110
  v_add_f32 v115, v115, v111
  v_add_f32 v112, v112, v114
  v_add_f32 v113, v113, v115
  s_nop 1
  v_add_f32_dpp v114, v112, v112 quad_perm:[1,0,3,2] row_mask:0xf bank_mask:0xf
  v_add_f32_dpp v115, v113, v113 quad_perm:[1,0,3,2] row_mask:0xf bank_mask:0xf
  v_mov_b32 v112, v114
  v_mov_b32 v113, v115
  s_nop 1
  v_add_f32_dpp v114, v112, v112 quad_perm:[2,3,0,1] row_mask:0xf bank_mask:0xf
  v_add_f32_dpp v115, v113, v113 quad_perm:[2,3,0,1] row_mask:0xf bank_mask:0xf
  v_mov_b32 v112, v114
  v_mov_b32 v113, v115
  s_nop 1
  v_add_f32_dpp v114, v112, v112 row_half_mirror row_mask:0xf bank_mask:0xf
  v_add_f32_dpp v115, v113, v113 row_half_mirror row_mask:0xf bank_mask:0xf
  v_mov_b32 v112, v114
  v_mov_b32 v113, v115
  s_nop 1
  v_add_f32_dpp v114, v112, v112 row_mirror row_mask:0xf bank_mask:0xf
  v_add_f32_dpp v115, v113, v113 row_mirror row_mask:0xf bank_mask:0xf
  v_mov_b32 v112, v114
  v_mov_b32 v113, v115
  s_nop 1
  v_permlane16_swap_b32 v114, v112
  v_permlane16_swap_b32 v115, v113
  v_add_f32 v112, v112, v114
  v_add_f32 v113, v113, v115
  v_mov_b32 v114, v112
  v_mov_b32 v115, v113
  s_nop 1
  v_permlane32_swap_b32 v114, v112
  v_permlane32_swap_b32 v115, v113
  v_add_f32 v112, v112, v114
  v_add_f32 v113, v113, v115
  v_mov_b32 v114, v112
  v_mov_b32 v115, v113
  v_mul_f32 v112, 0x3a800000, v112
  v_mul_f32 v113, 0x3a800000, v113
  v_sub_f32 v80, v80, v112
  v_sub_f32 v81, v81, v112
  v_sub_f32 v82, v82, v112
  v_sub_f32 v83, v83, v112
  v_sub_f32 v84, v84, v112
  v_sub_f32 v85, v85, v112
  v_sub_f32 v86, v86, v112
  v_sub_f32 v87, v87, v112
  v_sub_f32 v88, v88, v112
  v_sub_f32 v89, v89, v112
  v_sub_f32 v90, v90, v112
  v_sub_f32 v91, v91, v112
  v_sub_f32 v92, v92, v112
  v_sub_f32 v93, v93, v112
  v_sub_f32 v94, v94, v112
  v_sub_f32 v95, v95, v112
  v_sub_f32 v96, v96, v113
  v_sub_f32 v97, v97, v113
  v_sub_f32 v98, v98, v113
  v_sub_f32 v99, v99, v113
  v_sub_f32 v100, v100, v113
  v_sub_f32 v101, v101, v113
  v_sub_f32 v102, v102, v113
  v_sub_f32 v103, v103, v113
  v_sub_f32 v104, v104, v113
  v_sub_f32 v105, v105, v113
  v_sub_f32 v106, v106, v113
  v_sub_f32 v107, v107, v113
  v_sub_f32 v108, v108, v113
  v_sub_f32 v109, v109, v113
  v_sub_f32 v110, v110, v113
  v_sub_f32 v111, v111, v113
  v_mul_f32 v116, v80, v80
  v_mul_f32 v114, v81, v81
  v_mul_f32 v117, v96, v96
  v_mul_f32 v115, v97, v97
  v_fmac_f32 v116, v82, v82
  v_fmac_f32 v114, v83, v83
  v_fmac_f32 v117, v98, v98
  v_fmac_f32 v115, v99, v99
  v_fmac_f32 v116, v84, v84
  v_fmac_f32 v114, v85, v85
  v_fmac_f32 v117, v100, v100
  v_fmac_f32 v115, v101, v101
  v_fmac_f32 v116, v86, v86
  v_fmac_f32 v114, v87, v87
  v_fmac_f32 v117, v102, v102
  v_fmac_f32 v115, v103, v103
  v_fmac_f32 v116, v88, v88
  v_fmac_f32 v114, v89, v89
  v_fmac_f32 v117, v104, v104
  v_fmac_f32 v115, v105, v105
  v_fmac_f32 v116, v90, v90
  v_fmac_f32 v114, v91, v91
  v_fmac_f32 v117, v106, v106
  v_fmac_f32 v115, v107, v107
  v_fmac_f32 v116, v92, v92
  v_fmac_f32 v114, v93, v93
  v_fmac_f32 v117, v108, v108
  v_fmac_f32 v115, v109, v109
  v_fmac_f32 v116, v94, v94
  v_fmac_f32 v114, v95, v95
  v_fmac_f32 v117, v110, v110
  v_fmac_f32 v115, v111, v111
  v_add_f32 v116, v116, v114
  v_add_f32 v117, v117, v115
  s_nop 1
  v_add_f32_dpp v114, v116, v116 quad_perm:[1,0,3,2] row_mask:0xf bank_mask:0xf
  v_add_f32_dpp v115, v117, v117 quad_perm:[1,0,3,2] row_mask:0xf bank_mask:0xf
  v_mov_b32 v116, v114
  v_mov_b32 v117, v115
  s_nop 1
  v_add_f32_dpp v114, v116, v116 quad_perm:[2,3,0,1] row_mask:0xf bank_mask:0xf
  v_add_f32_dpp v115, v117, v117 quad_perm:[2,3,0,1] row_mask:0xf bank_mask:0xf
  v_mov_b32 v116, v114
  v_mov_b32 v117, v115
  s_nop 1
  v_add_f32_dpp v114, v116, v116 row_half_mirror row_mask:0xf bank_mask:0xf
  v_add_f32_dpp v115, v117, v117 row_half_mirror row_mask:0xf bank_mask:0xf
  v_mov_b32 v116, v114
  v_mov_b32 v117, v115
  s_nop 1
  v_add_f32_dpp v114, v116, v116 row_mirror row_mask:0xf bank_mask:0xf
  v_add_f32_dpp v115, v117, v117 row_mirror row_mask:0xf bank_mask:0xf
  v_mov_b32 v116, v114
  v_mov_b32 v117, v115
  s_nop 1
  v_permlane16_swap_b32 v114, v116
  v_permlane16_swap_b32 v115, v117
  v_add_f32 v116, v116, v114
  v_add_f32 v117, v117, v115
  v_mov_b32 v114, v116
  v_mov_b32 v115, v117
  s_nop 1
  v_permlane32_swap_b32 v114, v116
  v_permlane32_swap_b32 v115, v117
  v_add_f32 v116, v116, v114
  v_add_f32 v117, v117, v115
  v_mov_b32 v114, v116
  v_mov_b32 v115, v117
  v_mul_f32 v116, 0x3a800000, v116
  v_cvt_pk_bf16_f32 v116, v116, v116
  v_lshlrev_b32 v116, 16, v116
  v_add_f32 v116, 0x3727c5ac, v116
  v_cvt_pk_bf16_f32 v116, v116, v116
  v_lshlrev_b32 v116, 16, v116
  v_sqrt_f32 v116, v116
  s_nop 0
  v_cvt_pk_bf16_f32 v116, v116, v116
  v_lshlrev_b32 v116, 16, v116
  v_rcp_f32 v118, v116
  v_cvt_pk_bf16_f32 v112, v112, v112
  v_lshlrev_b32 v112, 16, v112
  v_mul_f32 v117, 0x3a800000, v117
  v_cvt_pk_bf16_f32 v117, v117, v117
  v_lshlrev_b32 v117, 16, v117
  v_add_f32 v117, 0x3727c5ac, v117
  v_cvt_pk_bf16_f32 v117, v117, v117
  v_lshlrev_b32 v117, 16, v117
  v_sqrt_f32 v117, v117
  s_nop 0
  v_cvt_pk_bf16_f32 v117, v117, v117
  v_lshlrev_b32 v117, 16, v117
  v_rcp_f32 v119, v117
  v_cvt_pk_bf16_f32 v113, v113, v113
  v_lshlrev_b32 v113, 16, v113
  s_nop 0
  v_mul_f32 v120, v112, v118
  v_sub_f32 v120, 0, v120
  v_mul_f32 v121, v113, v119
  v_sub_f32 v121, 0, v121
  s_lshl_b32 s52, s43, 3
  s_add_u32 s52, s52, 142400
  v_mov_b32 v145, s52
  s_mov_b64 s[58:59], exec
  s_mov_b64 exec, 1
  ds_write_b64 v145, v[118:119]
  ds_write_b64 v145, v[120:121] offset:32
  s_mov_b64 exec, s[58:59]
  s_cmp_lg_u32 s40, 4
  s_cbranch_scc1 Ltok_6
  v_lshlrev_b32 v146, 4, v144
  s_lshl_b32 s52, s42, 11
  s_add_u32 s12, s14, s52
  s_addc_u32 s13, s15, 0
  s_mov_b32 s32, s12
  s_and_b32 s33, s13, 0xffff
  s_mov_b32 s34, 0x800
  s_mov_b32 s35, 0x00020000
  s_mov_b32 m0, 135168
  s_nop 0
  buffer_load_dwordx4 v146, s[32:35], 0 offen lds
  s_nop 0
  buffer_load_dwordx4 v146, s[32:35], 0 offen offset:1024 lds
Ltok_6:
  s_waitcnt lgkmcnt(0)
Lhook_5:
  s_cmp_lg_u32 s40, 4
  s_cbranch_scc1 Lq2_8
  s_cmp_lg_u32 s50, 9
  s_cbranch_scc1 Lq_7
  s_load_dwordx2 s[78:79], s[8:9], 0
  s_lshl_b32 s52, s41, 11
  s_add_u32 s52, s52, 34013184
  v_and_b32 v151, 31, v144
  v_lshlrev_b32 v151, 6, v151
  v_add_u32 v151, s52, v151
  global_load_dwordx2 v[132:133], v151, s[4:5] sc1
Lq_7:
  s_cmp_lg_u32 s50, 11
  s_cbranch_scc1 Lq2_8
  s_waitcnt lgkmcnt(0)
  v_cmp_eq_u64 vcc, s[78:79], v[132:133]
  s_nop 4
  s_cmp_eq_u64 vcc, exec
  s_cbranch_scc0 Lq2_8
  s_cmp_eq_u64 s[78:79], 0
  s_cbranch_scc1 Lq2_8
  s_lshl_b32 s52, s41, 10
  s_add_u32 s52, s52, 29360128
  v_lshlrev_b32 v151, 4, v144
  v_add_u32 v151, s52, v151
  global_load_dwordx4 v[124:127], v151, s[4:5] sc1
  v_add_u32 v151, 8192, v151
  global_load_dwordx4 v[128:131], v151, s[4:5] sc1
  s_mov_b32 s73, 1
Lq2_8:
  s_add_u32 s50, s50, 1
  s_cmp_lt_u32 s50, 14
  s_cbranch_scc1 Lprod_4
  s_waitcnt vmcnt(11)
  s_barrier
  s_waitcnt vmcnt(0)
  s_barrier
  s_cmp_lg_u32 s40, 4
  s_cbranch_scc1 Lesync_9
  s_waitcnt lgkmcnt(0)
  v_mov_b32 v154, s78
  v_mov_b32 v155, s79
  s_mov_b32 s75, 0
Ltp_12:
  v_cmp_ne_u64 vcc, 0, v[154:155]
  s_nop 4
  s_cmp_eq_u64 vcc, exec
  s_cbranch_scc1 Ltokok_11
  s_add_u32 s75, s75, 1
  s_cmp_gt_u32 s75, 0x40000
  s_cbranch_scc1 Ltokok_11
  v_mov_b32 v149, 0
  global_load_dwordx2 v[154:155], v149, s[8:9] sc1
  s_waitcnt vmcnt(0)
  s_branch Ltp_12
Ltokok_11:
  s_cmp_eq_u32 s73, 1
  s_cbranch_scc1 Lgot_10
  s_mov_b32 s75, 0
Lpoll_13:
  s_lshl_b32 s52, s41, 11
  s_add_u32 s52, s52, 34013184
  v_and_b32 v151, 31, v144
  v_lshlrev_b32 v151, 6, v151
  v_add_u32 v151, s52, v151
  global_load_dwordx2 v[132:133], v151, s[4:5] sc1
  s_waitcnt vmcnt(0)
  v_cmp_eq_u64 vcc, v[154:155], v[132:133]
  s_nop 4
  s_cmp_eq_u64 vcc, exec
  s_cbranch_scc1 Lpolld_14
  s_add_u32 s75, s75, 1
  s_cmp_gt_u32 s75, 0x40000
  s_cbranch_scc1 Lpolld_14
  s_sleep 2
  s_branch Lpoll_13
Lpolld_14:
  s_lshl_b32 s52, s41, 10
  s_add_u32 s52, s52, 29360128
  v_lshlrev_b32 v151, 4, v144
  v_add_u32 v151, s52, v151
  global_load_dwordx4 v[124:127], v151, s[4:5] sc1
  v_add_u32 v151, 8192, v151
  global_load_dwordx4 v[128:131], v151, s[4:5] sc1
Lgot_10:
  v_mov_b32 v149, 142336
  ds_write_b64 v149, v[154:155]
  v_lshlrev_b32 v149, 4, v144
  v_add_u32 v149, 140288, v149
  s_waitcnt vmcnt(0)
  ds_write_b128 v149, v[124:127]
  ds_write_b128 v149, v[128:131] offset:1024
  s_waitcnt lgkmcnt(0)
Lesync_9:
  s_cmp_ge_u32 s40, 6
  s_cbranch_scc1 Lpfrole_15
  s_barrier
  s_barrier
  s_barrier
  v_mov_b32 v145, 142336
  ds_read_b64 v[40:41], v145
  s_lshl_b32 s52, s42, 9
  s_add_u32 s52, s52, 33554432
  v_and_b32 v145, 7, v144
  v_lshlrev_b32 v145, 6, v145
  v_add_u32 v145, s52, v145
  s_waitcnt lgkmcnt(0)
  s_mov_b32 s75, 0
Lpoll2_16:
  global_load_dwordx2 v[42:43], v145, s[4:5] sc1
  s_waitcnt vmcnt(0)
  v_cmp_eq_u64 vcc, v[40:41], v[42:43]
  s_nop 4
  s_cmp_eq_u64 vcc, exec
  s_cbranch_scc1 Lpoll2d_17
  s_add_u32 s75, s75, 1
  s_cmp_gt_u32 s75, 0x40000
  s_cbranch_scc1 Lpoll2d_17
  s_branch Lpoll2_16
Lpoll2d_17:
  s_lshl_b32 s52, s43, 12
  v_lshlrev_b32 v145, 4, v144
  v_add_u32 v145, s52, v145
  v_lshlrev_b32 v146, 4, v144
  v_add_u32 v146, 8192, v146
  v_cmp_gt_u32 vcc, 16, v144
  v_mov_b32 v147, 0x7fffffff
  s_nop 0
  v_cndmask_b32 v146, v147, v146, vcc
  s_mov_b32 s53, 0
  buffer_load_dwordx4 v[72:75], v145, s[28:31], s53 offen offset:0 sc1
  buffer_load_dwordx4 v[76:79], v145, s[28:31], s53 offen offset:1024 sc1
  buffer_load_dwordx4 v[80:83], v145, s[28:31], s53 offen offset:2048 sc1
  buffer_load_dwordx4 v[84:87], v145, s[28:31], s53 offen offset:3072 sc1
  s_mov_b32 s53, 8704
  buffer_load_dwordx4 v[88:91], v145, s[28:31], s53 offen offset:0 sc1
  buffer_load_dwordx4 v[92:95], v145, s[28:31], s53 offen offset:1024 sc1
  buffer_load_dwordx4 v[96:99], v145, s[28:31], s53 offen offset:2048 sc1
  buffer_load_dwordx4 v[100:103], v145, s[28:31], s53 offen offset:3072 sc1
  s_mov_b32 s53, 17408
  buffer_load_dwordx4 v[104:107], v145, s[28:31], s53 offen offset:0 sc1
  buffer_load_dwordx4 v[108:111], v145, s[28:31], s53 offen offset:1024 sc1
  buffer_load_dwordx4 v[112:115], v145, s[28:31], s53 offen offset:2048 sc1
  buffer_load_dwordx4 v[116:119], v145, s[28:31], s53 offen offset:3072 sc1
  s_mov_b32 s53, 26112
  buffer_load_dwordx4 v[120:123], v145, s[28:31], s53 offen offset:0 sc1
  buffer_load_dwordx4 v[124:127], v145, s[28:31], s53 offen offset:1024 sc1
  buffer_load_dwordx4 v[128:131], v145, s[28:31], s53 offen offset:2048 sc1
  buffer_load_dwordx4 v[132:135], v145, s[28:31], s53 offen offset:3072 sc1
  s_mov_b32 s53, 34816
  buffer_load_dwordx4 v[164:167], v145, s[28:31], s53 offen offset:0 sc1
  buffer_load_dwordx4 v[168:171], v145, s[28:31], s53 offen offset:1024 sc1
  buffer_load_dwordx4 v[172:175], v145, s[28:31], s53 offen offset:2048 sc1
  buffer_load_dwordx4 v[176:179], v145, s[28:31], s53 offen offset:3072 sc1
  s_mov_b32 s53, 43520
  buffer_load_dwordx4 v[180:183], v145, s[28:31], s53 offen offset:0 sc1
  buffer_load_dwordx4 v[184:187], v145, s[28:31], s53 offen offset:1024 sc1
  buffer_load_dwordx4 v[188:191], v145, s[28:31], s53 offen offset:2048 sc1
  buffer_load_dwordx4 v[192:195], v145, s[28:31], s53 offen offset:3072 sc1
  s_mov_b32 s53, 52224
  buffer_load_dwordx4 v[196:199], v145, s[28:31], s53 offen offset:0 sc1
  buffer_load_dwordx4 v[200:203], v145, s[28:31], s53 offen offset:1024 sc1
  buffer_load_dwordx4 v[204:207], v145, s[28:31], s53 offen offset:2048 sc1
  buffer_load_dwordx4 v[208:211], v145, s[28:31], s53 offen offset:3072 sc1
  s_mov_b32 s53, 60928
  buffer_load_dwordx4 v[212:215], v145, s[28:31], s53 offen offset:0 sc1
  buffer_load_dwordx4 v[216:219], v145, s[28:31], s53 offen offset:1024 sc1
  buffer_load_dwordx4 v[220:223], v145, s[28:31], s53 offen offset:2048 sc1
  buffer_load_dwordx4 v[224:227], v145, s[28:31], s53 offen offset:3072 sc1
  s_mov_b32 s53, 0
  buffer_load_dwordx4 v[40:43], v146, s[28:31], s53 offen sc1
  s_mov_b32 s53, 8704
  buffer_load_dwordx4 v[44:47], v146, s[28:31], s53 offen sc1
  s_mov_b32 s53, 17408
  buffer_load_dwordx4 v[48:51], v146, s[28:31], s53 offen sc1
  s_mov_b32 s53, 26112
  buffer_load_dwordx4 v[52:55], v146, s[28:31], s53 offen sc1
  s_mov_b32 s53, 34816
  buffer_load_dwordx4 v[56:59], v146, s[28:31], s53 offen sc1
  s_mov_b32 s53, 43520
  buffer_load_dwordx4 v[60:63], v146, s[28:31], s53 offen sc1
  s_mov_b32 s53, 52224
  buffer_load_dwordx4 v[64:67], v146, s[28:31], s53 offen sc1
  s_mov_b32 s53, 60928
  buffer_load_dwordx4 v[68:71], v146, s[28:31], s53 offen sc1
  s_waitcnt vmcnt(32)
  v_pk_add_f32 v[72:73], v[72:73], v[88:89]
  v_pk_add_f32 v[74:75], v[74:75], v[90:91]
  v_pk_add_f32 v[76:77], v[76:77], v[92:93]
  v_pk_add_f32 v[78:79], v[78:79], v[94:95]
  v_pk_add_f32 v[80:81], v[80:81], v[96:97]
  v_pk_add_f32 v[82:83], v[82:83], v[98:99]
  v_pk_add_f32 v[84:85], v[84:85], v[100:101]
  v_pk_add_f32 v[86:87], v[86:87], v[102:103]
  s_waitcnt vmcnt(28)
  v_pk_add_f32 v[72:73], v[72:73], v[104:105]
  v_pk_add_f32 v[74:75], v[74:75], v[106:107]
  v_pk_add_f32 v[76:77], v[76:77], v[108:109]
  v_pk_add_f32 v[78:79], v[78:79], v[110:111]
  v_pk_add_f32 v[80:81], v[80:81], v[112:113]
  v_pk_add_f32 v[82:83], v[82:83], v[114:115]
  v_pk_add_f32 v[84:85], v[84:85], v[116:117]
  v_pk_add_f32 v[86:87], v[86:87], v[118:119]
  s_waitcnt vmcnt(24)
  v_pk_add_f32 v[72:73], v[72:73], v[120:121]
  v_pk_add_f32 v[74:75], v[74:75], v[122:123]
  v_pk_add_f32 v[76:77], v[76:77], v[124:125]
  v_pk_add_f32 v[78:79], v[78:79], v[126:127]
  v_pk_add_f32 v[80:81], v[80:81], v[128:129]
  v_pk_add_f32 v[82:83], v[82:83], v[130:131]
  v_pk_add_f32 v[84:85], v[84:85], v[132:133]
  v_pk_add_f32 v[86:87], v[86:87], v[134:135]
  s_waitcnt vmcnt(20)
  v_pk_add_f32 v[72:73], v[72:73], v[164:165]
  v_pk_add_f32 v[74:75], v[74:75], v[166:167]
  v_pk_add_f32 v[76:77], v[76:77], v[168:169]
  v_pk_add_f32 v[78:79], v[78:79], v[170:171]
  v_pk_add_f32 v[80:81], v[80:81], v[172:173]
  v_pk_add_f32 v[82:83], v[82:83], v[174:175]
  v_pk_add_f32 v[84:85], v[84:85], v[176:177]
  v_pk_add_f32 v[86:87], v[86:87], v[178:179]
  s_waitcnt vmcnt(16)
  v_pk_add_f32 v[72:73], v[72:73], v[180:181]
  v_pk_add_f32 v[74:75], v[74:75], v[182:183]
  v_pk_add_f32 v[76:77], v[76:77], v[184:185]
  v_pk_add_f32 v[78:79], v[78:79], v[186:187]
  v_pk_add_f32 v[80:81], v[80:81], v[188:189]
  v_pk_add_f32 v[82:83], v[82:83], v[190:191]
  v_pk_add_f32 v[84:85], v[84:85], v[192:193]
  v_pk_add_f32 v[86:87], v[86:87], v[194:195]
  s_waitcnt vmcnt(12)
  v_pk_add_f32 v[72:73], v[72:73], v[196:197]
  v_pk_add_f32 v[74:75], v[74:75], v[198:199]
  v_pk_add_f32 v[76:77], v[76:77], v[200:201]
  v_pk_add_f32 v[78:79], v[78:79], v[202:203]
  v_pk_add_f32 v[80:81], v[80:81], v[204:205]
  v_pk_add_f32 v[82:83], v[82:83], v[206:207]
  v_pk_add_f32 v[84:85], v[84:85], v[208:209]
  v_pk_add_f32 v[86:87], v[86:87], v[210:211]
  s_waitcnt vmcnt(8)
  v_pk_add_f32 v[72:73], v[72:73], v[212:213]
  v_pk_add_f32 v[74:75], v[74:75], v[214:215]
  v_pk_add_f32 v[76:77], v[76:77], v[216:217]
  v_pk_add_f32 v[78:79], v[78:79], v[218:219]
  v_pk_add_f32 v[80:81], v[80:81], v[220:221]
  v_pk_add_f32 v[82:83], v[82:83], v[222:223]
  v_pk_add_f32 v[84:85], v[84:85], v[224:225]
  v_pk_add_f32 v[86:87], v[86:87], v[226:227]
  v_cvt_pk_bf16_f32 v228, v72, v73
  v_cvt_pk_bf16_f32 v229, v74, v75
  v_cvt_pk_bf16_f32 v230, v76, v77
  v_cvt_pk_bf16_f32 v231, v78, v79
  v_cvt_pk_bf16_f32 v232, v80, v81
  v_cvt_pk_bf16_f32 v233, v82, v83
  v_cvt_pk_bf16_f32 v234, v84, v85
  v_cvt_pk_bf16_f32 v235, v86, v87
  s_lshl_b32 s52, s43, 11
  s_add_u32 s52, s52, 71680
  v_lshlrev_b32 v145, 4, v144
  v_add_u32 v145, s52, v145
  ds_write_b128 v145, v[228:231]
  ds_write_b128 v145, v[232:235] offset:1024
  s_waitcnt vmcnt(0)
  v_pk_add_f32 v[40:41], v[40:41], v[44:45]
  v_pk_add_f32 v[42:43], v[42:43], v[46:47]
  v_pk_add_f32 v[40:41], v[40:41], v[48:49]
  v_pk_add_f32 v[42:43], v[42:43], v[50:51]
  v_pk_add_f32 v[40:41], v[40:41], v[52:53]
  v_pk_add_f32 v[42:43], v[42:43], v[54:55]
  v_pk_add_f32 v[40:41], v[40:41], v[56:57]
  v_pk_add_f32 v[42:43], v[42:43], v[58:59]
  v_pk_add_f32 v[40:41], v[40:41], v[60:61]
  v_pk_add_f32 v[42:43], v[42:43], v[62:63]
  v_pk_add_f32 v[40:41], v[40:41], v[64:65]
  v_pk_add_f32 v[42:43], v[42:43], v[66:67]
  v_pk_add_f32 v[40:41], v[40:41], v[68:69]
  v_pk_add_f32 v[42:43], v[42:43], v[70:71]
  v_cvt_pk_bf16_f32 v44, v40, v41
  v_cvt_pk_bf16_f32 v45, v42, v43
  v_lshrrev_b32 v145, 2, v144
  v_lshlrev_b32 v145, 5, v145
  v_and_b32 v146, 1, v144
  v_lshl_add_u32 v145, v146, 4, v145
  v_bfe_u32 v146, v144, 1, 1
  v_lshl_add_u32 v145, v146, 3, v145
  v_add_u32 v145, 75776, v145
  v_cmp_gt_u32 vcc, 16, v144
  s_and_saveexec_b64 s[58:59], vcc
  ds_write_b64 v145, v[44:45]
  s_mov_b64 exec, s[58:59]
  s_waitcnt lgkmcnt(0)
  s_barrier
  s_branch Ljoin_2
Lpfrole_15:
  s_lshl_b32 s72, s2, 1
  s_add_u32 s72, s72, s40
  s_sub_u32 s72, s72, 6
  s_mov_b32 s32, s64
  s_and_b32 s33, s65, 0xffff
  s_mov_b32 s34, 0x700000
  s_mov_b32 s35, 0x00020000
  s_barrier
  s_lshl_b32 s52, s72, 1
  s_mul_i32 s53, s52, 1171
  s_lshr_b32 s76, s53, 16
  s_mul_i32 s54, s76, 56
  s_sub_u32 s77, s52, s54
  s_lshl_b32 s55, s76, 6
  v_lshrrev_b32 v145, 3, v144
  v_add_u32 v145, s55, v145
  s_mov_b32 s55, 7168
  v_mul_lo_u32 v145, v145, s55
  v_and_b32 v146, 7, v144
  v_lshlrev_b32 v146, 4, v146
  s_lshl_b32 s55, s77, 7
  v_add3_u32 v60, v145, v146, s55
  s_mov_b32 s55, 0
  buffer_load_dwordx4 v[164:167], v60, s[32:35], s55 offen
  s_mov_b32 s55, 57344
  buffer_load_dwordx4 v[168:171], v60, s[32:35], s55 offen
  s_mov_b32 s55, 114688
  buffer_load_dwordx4 v[172:175], v60, s[32:35], s55 offen
  s_mov_b32 s55, 172032
  buffer_load_dwordx4 v[176:179], v60, s[32:35], s55 offen
  s_mov_b32 s55, 229376
  buffer_load_dwordx4 v[180:183], v60, s[32:35], s55 offen
  s_mov_b32 s55, 286720
  buffer_load_dwordx4 v[184:187], v60, s[32:35], s55 offen
  s_mov_b32 s55, 344064
  buffer_load_dwordx4 v[188:191], v60, s[32:35], s55 offen
  s_mov_b32 s55, 401408
  buffer_load_dwordx4 v[192:195], v60, s[32:35], s55 offen
  s_lshl_b32 s52, s72, 1
  s_add_u32 s52, s52, 1
  s_mul_i32 s53, s52, 1171
  s_lshr_b32 s78, s53, 16
  s_mul_i32 s54, s78, 56
  s_sub_u32 s79, s52, s54
  s_lshl_b32 s55, s78, 6
  v_lshrrev_b32 v145, 3, v144
  v_add_u32 v145, s55, v145
  s_mov_b32 s55, 7168
  v_mul_lo_u32 v145, v145, s55
  v_and_b32 v146, 7, v144
  v_lshlrev_b32 v146, 4, v146
  s_lshl_b32 s55, s79, 7
  v_add3_u32 v61, v145, v146, s55
  s_mov_b32 s55, 0
  buffer_load_dwordx4 v[196:199], v61, s[32:35], s55 offen
  s_mov_b32 s55, 57344
  buffer_load_dwordx4 v[200:203], v61, s[32:35], s55 offen
  s_mov_b32 s55, 114688
  buffer_load_dwordx4 v[204:207], v61, s[32:35], s55 offen
  s_mov_b32 s55, 172032
  buffer_load_dwordx4 v[208:211], v61, s[32:35], s55 offen
  s_mov_b32 s55, 229376
  buffer_load_dwordx4 v[212:215], v61, s[32:35], s55 offen
  s_mov_b32 s55, 286720
  buffer_load_dwordx4 v[216:219], v61, s[32:35], s55 offen
  s_mov_b32 s55, 344064
  buffer_load_dwordx4 v[220:223], v61, s[32:35], s55 offen
  s_mov_b32 s55, 401408
  buffer_load_dwordx4 v[224:227], v61, s[32:35], s55 offen
  s_barrier
  s_barrier
  v_lshlrev_b32 v62, 4, v144
  s_lshl_b32 s55, s72, 12
  v_add_u32 v63, s55, v62
  global_load_dwordx4 v[228:231], v63, s[68:69] offset:0
  global_load_dwordx4 v[232:235], v63, s[68:69] offset:1024
  global_load_dwordx4 v[236:239], v63, s[68:69] offset:2048
  global_load_dwordx4 v[240:243], v63, s[68:69] offset:3072
  s_mul_i32 s55, s72, 14336
  v_add_u32 v63, s55, v62
  s_barrier
  s_branch Ljoin_2
Lconsumer_3:
  s_or_b32 s58, s2, s40
  s_cmp_lg_u32 s58, 0
  s_cbranch_scc1 Ltok0_18
  s_memrealtime s[58:59]
  s_waitcnt lgkmcnt(0)
  s_or_b32 s58, s58, 1
  v_mov_b32 v154, s58
  v_mov_b32 v155, s59
  v_mov_b32 v145, 0
  s_mov_b64 s[58:59], exec
  s_mov_b64 exec, 1
  global_store_dwordx2 v145, v[154:155], s[8:9] sc1
  s_mov_b64 exec, s[58:59]
Ltok0_18:
  v_and_b32 v145, 31, v144
  v_lshrrev_b32 v146, 5, v144
  v_bfe_u32 v147, v145, 1, 3
  s_lshl_b32 s54, s40, 6
  v_add_u32 v148, s54, v145
  v_lshlrev_b32 v148, 7, v148
  v_add_u32 v149, 0, v146
  v_xor_b32 v149, v149, v147
  v_lshl_add_u32 v139, v149, 4, v148
  v_add_u32 v149, 2, v146
  v_xor_b32 v149, v149, v147
  v_lshl_add_u32 v140, v149, 4, v148
  v_add_u32 v149, 4, v146
  v_xor_b32 v149, v149, v147
  v_lshl_add_u32 v141, v149, 4, v148
  v_add_u32 v149, 6, v146
  v_xor_b32 v149, v149, v147
  v_lshl_add_u32 v142, v149, 4, v148
  v_lshrrev_b32 v145, 4, v144
  v_and_b32 v146, 15, v144
  v_lshrrev_b32 v147, 2, v146
  v_lshrrev_b32 v148, 1, v145
  v_lshl_add_u32 v147, v148, 3, v147
  v_mul_u32_u24 v147, 192, v147
  v_and_b32 v145, 1, v145
  v_lshl_add_u32 v147, v145, 5, v147
  v_and_b32 v146, 3, v146
  v_lshl_add_u32 v147, v146, 3, v147
  v_add_u32 v143, 98304, v147
  v_mov_b32 v0, 0
  v_mov_b32 v1, 0
  v_mov_b32 v2, 0
  v_mov_b32 v3, 0
  v_mov_b32 v4, 0
  v_mov_b32 v5, 0
  v_mov_b32 v6, 0
  v_mov_b32 v7, 0
  v_mov_b32 v8, 0
  v_mov_b32 v9, 0
  v_mov_b32 v10, 0
  v_mov_b32 v11, 0
  v_mov_b32 v12, 0
  v_mov_b32 v13, 0
  v_mov_b32 v14, 0
  v_mov_b32 v15, 0
  v_mov_b32 v16, 0
  v_mov_b32 v17, 0
  v_mov_b32 v18, 0
  v_mov_b32 v19, 0
  v_mov_b32 v20, 0
  v_mov_b32 v21, 0
  v_mov_b32 v22, 0
  v_mov_b32 v23, 0
  v_mov_b32 v24, 0
  v_mov_b32 v25, 0
  v_mov_b32 v26, 0
  v_mov_b32 v27, 0
  v_mov_b32 v28, 0
  v_mov_b32 v29, 0
  v_mov_b32 v30, 0
  v_mov_b32 v31, 0
  v_mov_b32 v32, 0
  v_mov_b32 v33, 0
  v_mov_b32 v34, 0
  v_mov_b32 v35, 0
  v_mov_b32 v36, 0
  v_mov_b32 v37, 0
  v_mov_b32 v38, 0
  v_mov_b32 v39, 0
  v_mov_b32 v40, 0
  v_mov_b32 v41, 0
  v_mov_b32 v42, 0
  v_mov_b32 v43, 0
  v_mov_b32 v44, 0
  v_mov_b32 v45, 0
  v_mov_b32 v46, 0
  v_mov_b32 v47, 0
  v_mov_b32 v48, 0
  v_mov_b32 v49, 0
  v_mov_b32 v50, 0
  v_mov_b32 v51, 0
  v_mov_b32 v52, 0
  v_mov_b32 v53, 0
  v_mov_b32 v54, 0
  v_mov_b32 v55, 0
  v_mov_b32 v56, 0
  v_mov_b32 v57, 0
  v_mov_b32 v58, 0
  v_mov_b32 v59, 0
  v_mov_b32 v60, 0
  v_mov_b32 v61, 0
  v_mov_b32 v62, 0
  v_mov_b32 v63, 0
  v_mov_b32 v64, 0
  v_mov_b32 v65, 0
  v_mov_b32 v66, 0
  v_mov_b32 v67, 0
  v_mov_b32 v68, 0
  v_mov_b32 v69, 0
  v_mov_b32 v70, 0
  v_mov_b32 v71, 0
  v_mov_b32 v72, 0
  v_mov_b32 v73, 0
  v_mov_b32 v74, 0
  v_mov_b32 v75, 0
  v_mov_b32 v76, 0
  v_mov_b32 v77, 0
  v_mov_b32 v78, 0
  v_mov_b32 v79, 0
  v_mov_b32 v80, 0
  v_mov_b32 v81, 0
  v_mov_b32 v82, 0
  v_mov_b32 v83, 0
  v_mov_b32 v84, 0
  v_mov_b32 v85, 0
  v_mov_b32 v86, 0
  v_mov_b32 v87, 0
  v_mov_b32 v88, 0
  v_mov_b32 v89, 0
  v_mov_b32 v90, 0
  v_mov_b32 v91, 0
  v_mov_b32 v92, 0
  v_mov_b32 v93, 0
  v_mov_b32 v94, 0
  v_mov_b32 v95, 0
  v_mov_b32 v136, 0
  v_mov_b32 v137, 0
  v_mov_b32 v138, 0
  s_mov_b32 s45, 0
  s_mov_b32 s51, 0
  s_mov_b32 s50, 0
  s_waitcnt lgkmcnt(0)
  s_cmp_eq_u32 s40, 1
  s_cbranch_scc1 Lw_21
  s_cmp_eq_u32 s40, 2
  s_cbranch_scc1 Lw_22
  s_cmp_eq_u32 s40, 3
  s_cbranch_scc1 Lw_23
Lw_20:
  s_barrier
  ds_read_b64_tr_b16 v[104:105], v143 offset:0
  ds_read_b64_tr_b16 v[106:107], v143 offset:768
  ds_read_b128 v[96:99], v139 offset:0
  ds_read_b64_tr_b16 v[108:109], v143 offset:64
  ds_read_b64_tr_b16 v[110:111], v143 offset:832
  ds_read_b128 v[100:103], v139 offset:4096
  ds_read_b64_tr_b16 v[112:113], v143 offset:128
  ds_read_b64_tr_b16 v[114:115], v143 offset:896
  ds_read_b64_tr_b16 v[124:125], v143 offset:3072
  ds_read_b64_tr_b16 v[126:127], v143 offset:3840
  ds_read_b128 v[116:119], v140 offset:0
  ds_read_b64_tr_b16 v[128:129], v143 offset:3136
  ds_read_b64_tr_b16 v[130:131], v143 offset:3904
  ds_read_b128 v[120:123], v140 offset:4096
  ds_read_b64_tr_b16 v[132:133], v143 offset:3200
  ds_read_b64_tr_b16 v[134:135], v143 offset:3968
Lk1_24:
  s_waitcnt lgkmcnt(8)
  v_mfma_f32_32x32x16_bf16 v[0:15], v[104:107], v[96:99], v[0:15]
  ds_read_b64_tr_b16 v[184:185], v143 offset:6144
  ds_read_b64_tr_b16 v[186:187], v143 offset:6912
  ds_read_b128 v[176:179], v141 offset:0
  v_lshlrev_b32 v145, 16, v104
  v_and_b32 v146, 0xffff0000, v104
  v_mfma_f32_32x32x16_bf16 v[32:47], v[108:111], v[96:99], v[32:47]
  ds_read_b64_tr_b16 v[188:189], v143 offset:6208
  ds_read_b64_tr_b16 v[190:191], v143 offset:6976
  ds_read_b128 v[180:183], v141 offset:4096
  v_add_f32 v136, v136, v145
  v_add_f32 v136, v136, v146
  v_mfma_f32_32x32x16_bf16 v[16:31], v[104:107], v[100:103], v[16:31]
  ds_read_b64_tr_b16 v[192:193], v143 offset:6272
  ds_read_b64_tr_b16 v[194:195], v143 offset:7040
  v_lshlrev_b32 v147, 16, v108
  v_and_b32 v148, 0xffff0000, v108
  v_mfma_f32_32x32x16_bf16 v[48:63], v[108:111], v[100:103], v[48:63]
  v_add_f32 v137, v137, v147
  v_add_f32 v137, v137, v148
  v_lshlrev_b32 v145, 16, v112
  v_mfma_f32_32x32x16_bf16 v[64:79], v[96:99], v[112:115], v[64:79]
  v_and_b32 v146, 0xffff0000, v112
  v_add_f32 v138, v138, v145
  v_add_f32 v138, v138, v146
  v_mfma_f32_32x32x16_bf16 v[80:95], v[100:103], v[112:115], v[80:95]
  s_waitcnt lgkmcnt(8)
  v_mfma_f32_32x32x16_bf16 v[0:15], v[124:127], v[116:119], v[0:15]
  ds_read_b64_tr_b16 v[204:205], v143 offset:9216
  ds_read_b64_tr_b16 v[206:207], v143 offset:9984
  ds_read_b128 v[196:199], v142 offset:0
  v_lshlrev_b32 v145, 16, v124
  v_and_b32 v146, 0xffff0000, v124
  v_mfma_f32_32x32x16_bf16 v[32:47], v[128:131], v[116:119], v[32:47]
  ds_read_b64_tr_b16 v[208:209], v143 offset:9280
  ds_read_b64_tr_b16 v[210:211], v143 offset:10048
  ds_read_b128 v[200:203], v142 offset:4096
  v_add_f32 v136, v136, v145
  v_add_f32 v136, v136, v146
  v_mfma_f32_32x32x16_bf16 v[16:31], v[124:127], v[120:123], v[16:31]
  ds_read_b64_tr_b16 v[212:213], v143 offset:9344
  ds_read_b64_tr_b16 v[214:215], v143 offset:10112
  v_lshlrev_b32 v147, 16, v128
  v_and_b32 v148, 0xffff0000, v128
  v_mfma_f32_32x32x16_bf16 v[48:63], v[128:131], v[120:123], v[48:63]
  v_add_f32 v137, v137, v147
  v_add_f32 v137, v137, v148
  v_lshlrev_b32 v145, 16, v132
  v_mfma_f32_32x32x16_bf16 v[64:79], v[116:119], v[132:135], v[64:79]
  v_and_b32 v146, 0xffff0000, v132
  v_add_f32 v138, v138, v145
  v_add_f32 v138, v138, v146
  v_mfma_f32_32x32x16_bf16 v[80:95], v[120:123], v[132:135], v[80:95]
  s_waitcnt lgkmcnt(0)
  s_barrier
  s_add_u32 s45, s45, 32768
  s_mov_b32 s46, 32768
  s_cmp_eq_u32 s45, 98304
  s_cselect_b32 s45, 0, s45
  s_cselect_b32 s46, -65536, s46
  s_add_u32 s51, s51, 12288
  s_mov_b32 s47, 12288
  s_cmp_eq_u32 s51, 36864
  s_cselect_b32 s51, 0, s51
  s_cselect_b32 s47, -24576, s47
  v_add_u32 v139, s46, v139
  v_add_u32 v140, s46, v140
  v_add_u32 v141, s46, v141
  v_add_u32 v142, s46, v142
  v_add_u32 v143, s47, v143
  s_cmp_lg_u32 s50, 1
  s_cbranch_scc1 Lh1_25
  v_lshlrev_b32 v164, 2, v144
  v_add_u32 v165, 142400, v164
  ds_read_b32 v166, v165
  ds_read_b32 v167, v165 offset:32
  s_lshl_b32 s52, s41, 8
  s_lshl_b32 s53, s42, 3
  s_add_u32 s52, s52, s53
  s_lshl_b32 s52, s52, 2
  s_add_u32 s52, s52, 29360128
  v_add_u32 v164, s52, v164
  v_add_u32 v165, 8192, v164
  s_waitcnt lgkmcnt(0)
  s_mov_b64 s[58:59], exec
  s_mov_b64 exec, 0xff
  global_store_dword v164, v166, s[4:5] sc1
  global_store_dword v165, v167, s[4:5] sc1
  s_mov_b64 exec, s[58:59]
Lh1_25:
  s_cmp_lg_u32 s50, 3
  s_cbranch_scc1 Lh3_27
  s_load_dwordx2 s[78:79], s[8:9], 0
Lh3_27:
  s_cmp_lg_u32 s50, 5
  s_cbranch_scc1 Lh2_26
  s_waitcnt vmcnt(0) lgkmcnt(0)
  v_mov_b32 v154, s78
  v_mov_b32 v155, s79
  s_mov_b32 s75, 0
Ltp0_28:
  v_cmp_ne_u64 vcc, 0, v[154:155]
  s_nop 4
  s_cmp_eq_u64 vcc, exec
  s_cbranch_scc1 Ltd0_29
  s_add_u32 s75, s75, 1
  s_cmp_gt_u32 s75, 0x40000
  s_cbranch_scc1 Ltd0_29
  v_mov_b32 v164, 0
  global_load_dwordx2 v[154:155], v164, s[8:9] sc1
  s_waitcnt vmcnt(0)
  s_branch Ltp0_28
Ltd0_29:
  s_lshl_b32 s52, s41, 5
  s_add_u32 s52, s52, s42
  s_lshl_b32 s52, s52, 6
  s_add_u32 s52, s52, 34013184
  v_lshlrev_b32 v164, 3, v144
  v_add_u32 v164, s52, v164
  s_mov_b64 s[58:59], exec
  s_mov_b64 exec, 0xff
  global_store_dwordx2 v164, v[154:155], s[4:5] sc1
  s_mov_b64 exec, s[58:59]
Lh2_26:
  v_mfma_f32_32x32x16_bf16 v[0:15], v[184:187], v[176:179], v[0:15]
  ds_read_b64_tr_b16 v[104:105], v143 offset:0
  ds_read_b64_tr_b16 v[106:107], v143 offset:768
  ds_read_b128 v[96:99], v139 offset:0
  v_lshlrev_b32 v145, 16, v184
  v_and_b32 v146, 0xffff0000, v184
  v_mfma_f32_32x32x16_bf16 v[32:47], v[188:191], v[176:179], v[32:47]
  ds_read_b64_tr_b16 v[108:109], v143 offset:64
  ds_read_b64_tr_b16 v[110:111], v143 offset:832
  ds_read_b128 v[100:103], v139 offset:4096
  v_add_f32 v136, v136, v145
  v_add_f32 v136, v136, v146
  v_mfma_f32_32x32x16_bf16 v[16:31], v[184:187], v[180:183], v[16:31]
  ds_read_b64_tr_b16 v[112:113], v143 offset:128
  ds_read_b64_tr_b16 v[114:115], v143 offset:896
  v_lshlrev_b32 v147, 16, v188
  v_and_b32 v148, 0xffff0000, v188
  v_mfma_f32_32x32x16_bf16 v[48:63], v[188:191], v[180:183], v[48:63]
  v_add_f32 v137, v137, v147
  v_add_f32 v137, v137, v148
  v_lshlrev_b32 v145, 16, v192
  v_mfma_f32_32x32x16_bf16 v[64:79], v[176:179], v[192:195], v[64:79]
  v_and_b32 v146, 0xffff0000, v192
  v_add_f32 v138, v138, v145
  v_add_f32 v138, v138, v146
  v_mfma_f32_32x32x16_bf16 v[80:95], v[180:183], v[192:195], v[80:95]
  s_nop 0
  v_mfma_f32_32x32x16_bf16 v[0:15], v[204:207], v[196:199], v[0:15]
  ds_read_b64_tr_b16 v[124:125], v143 offset:3072
  ds_read_b64_tr_b16 v[126:127], v143 offset:3840
  ds_read_b128 v[116:119], v140 offset:0
  v_lshlrev_b32 v145, 16, v204
  v_and_b32 v146, 0xffff0000, v204
  v_mfma_f32_32x32x16_bf16 v[32:47], v[208:211], v[196:199], v[32:47]
  ds_read_b64_tr_b16 v[128:129], v143 offset:3136
  ds_read_b64_tr_b16 v[130:131], v143 offset:3904
  ds_read_b128 v[120:123], v140 offset:4096
  v_add_f32 v136, v136, v145
  v_add_f32 v136, v136, v146
  v_mfma_f32_32x32x16_bf16 v[16:31], v[204:207], v[200:203], v[16:31]
  ds_read_b64_tr_b16 v[132:133], v143 offset:3200
  ds_read_b64_tr_b16 v[134:135], v143 offset:3968
  v_lshlrev_b32 v147, 16, v208
  v_and_b32 v148, 0xffff0000, v208
  v_mfma_f32_32x32x16_bf16 v[48:63], v[208:211], v[200:203], v[48:63]
  v_add_f32 v137, v137, v147
  v_add_f32 v137, v137, v148
  v_lshlrev_b32 v145, 16, v212
  v_mfma_f32_32x32x16_bf16 v[64:79], v[196:199], v[212:215], v[64:79]
  v_and_b32 v146, 0xffff0000, v212
  v_add_f32 v138, v138, v145
  v_add_f32 v138, v138, v146
  v_mfma_f32_32x32x16_bf16 v[80:95], v[200:203], v[212:215], v[80:95]
  s_add_u32 s50, s50, 1
  s_cmp_lt_u32 s50, 15
  s_cbranch_scc1 Lk1_24
  s_waitcnt lgkmcnt(8)
  v_mfma_f32_32x32x16_bf16 v[0:15], v[104:107], v[96:99], v[0:15]
  ds_read_b64_tr_b16 v[184:185], v143 offset:6144
  ds_read_b64_tr_b16 v[186:187], v143 offset:6912
  ds_read_b128 v[176:179], v141 offset:0
  v_lshlrev_b32 v145, 16, v104
  v_and_b32 v146, 0xffff0000, v104
  v_mfma_f32_32x32x16_bf16 v[32:47], v[108:111], v[96:99], v[32:47]
  ds_read_b64_tr_b16 v[188:189], v143 offset:6208
  ds_read_b64_tr_b16 v[190:191], v143 offset:6976
  ds_read_b128 v[180:183], v141 offset:4096
  v_add_f32 v136, v136, v145
  v_add_f32 v136, v136, v146
  v_mfma_f32_32x32x16_bf16 v[16:31], v[104:107], v[100:103], v[16:31]
  ds_read_b64_tr_b16 v[192:193], v143 offset:6272
  ds_read_b64_tr_b16 v[194:195], v143 offset:7040
  v_lshlrev_b32 v147, 16, v108
  v_and_b32 v148, 0xffff0000, v108
  v_mfma_f32_32x32x16_bf16 v[48:63], v[108:111], v[100:103], v[48:63]
  v_add_f32 v137, v137, v147
  v_add_f32 v137, v137, v148
  v_lshlrev_b32 v145, 16, v112
  v_mfma_f32_32x32x16_bf16 v[64:79], v[96:99], v[112:115], v[64:79]
  v_and_b32 v146, 0xffff0000, v112
  v_add_f32 v138, v138, v145
  v_add_f32 v138, v138, v146
  v_mfma_f32_32x32x16_bf16 v[80:95], v[100:103], v[112:115], v[80:95]
  s_waitcnt lgkmcnt(8)
  v_mfma_f32_32x32x16_bf16 v[0:15], v[124:127], v[116:119], v[0:15]
  ds_read_b64_tr_b16 v[204:205], v143 offset:9216
  ds_read_b64_tr_b16 v[206:207], v143 offset:9984
  ds_read_b128 v[196:199], v142 offset:0
  v_lshlrev_b32 v145, 16, v124
  v_and_b32 v146, 0xffff0000, v124
  v_mfma_f32_32x32x16_bf16 v[32:47], v[128:131], v[116:119], v[32:47]
  ds_read_b64_tr_b16 v[208:209], v143 offset:9280
  ds_read_b64_tr_b16 v[210:211], v143 offset:10048
  ds_read_b128 v[200:203], v142 offset:4096
  v_add_f32 v136, v136, v145
  v_add_f32 v136, v136, v146
  v_mfma_f32_32x32x16_bf16 v[16:31], v[124:127], v[120:123], v[16:31]
  ds_read_b64_tr_b16 v[212:213], v143 offset:9344
  ds_read_b64_tr_b16 v[214:215], v143 offset:10112
  v_lshlrev_b32 v147, 16, v128
  v_and_b32 v148, 0xffff0000, v128
  v_mfma_f32_32x32x16_bf16 v[48:63], v[128:131], v[120:123], v[48:63]
  v_add_f32 v137, v137, v147
  v_add_f32 v137, v137, v148
  v_lshlrev_b32 v145, 16, v132
  v_mfma_f32_32x32x16_bf16 v[64:79], v[116:119], v[132:135], v[64:79]
  v_and_b32 v146, 0xffff0000, v132
  v_add_f32 v138, v138, v145
  v_add_f32 v138, v138, v146
  v_mfma_f32_32x32x16_bf16 v[80:95], v[120:123], v[132:135], v[80:95]
  s_waitcnt lgkmcnt(8)
  v_mfma_f32_32x32x16_bf16 v[0:15], v[184:187], v[176:179], v[0:15]
  v_lshlrev_b32 v145, 16, v184
  v_and_b32 v146, 0xffff0000, v184
  v_mfma_f32_32x32x16_bf16 v[32:47], v[188:191], v[176:179], v[32:47]
  v_add_f32 v136, v136, v145
  v_add_f32 v136, v136, v146
  v_mfma_f32_32x32x16_bf16 v[16:31], v[184:187], v[180:183], v[16:31]
  v_lshlrev_b32 v147, 16, v188
  v_and_b32 v148, 0xffff0000, v188
  v_mfma_f32_32x32x16_bf16 v[48:63], v[188:191], v[180:183], v[48:63]
  v_add_f32 v137, v137, v147
  v_add_f32 v137, v137, v148
  v_lshlrev_b32 v145, 16, v192
  v_mfma_f32_32x32x16_bf16 v[64:79], v[176:179], v[192:195], v[64:79]
  v_and_b32 v146, 0xffff0000, v192
  v_add_f32 v138, v138, v145
  v_add_f32 v138, v138, v146
  v_mfma_f32_32x32x16_bf16 v[80:95], v[180:183], v[192:195], v[80:95]
  s_waitcnt lgkmcnt(0)
  v_mfma_f32_32x32x16_bf16 v[0:15], v[204:207], v[196:199], v[0:15]
  v_lshlrev_b32 v145, 16, v204
  v_and_b32 v146, 0xffff0000, v204
  v_mfma_f32_32x32x16_bf16 v[32:47], v[208:211], v[196:199], v[32:47]
  v_add_f32 v136, v136, v145
  v_add_f32 v136, v136, v146
  v_mfma_f32_32x32x16_bf16 v[16:31], v[204:207], v[200:203], v[16:31]
  v_lshlrev_b32 v147, 16, v208
  v_and_b32 v148, 0xffff0000, v208
  v_mfma_f32_32x32x16_bf16 v[48:63], v[208:211], v[200:203], v[48:63]
  v_add_f32 v137, v137, v147
  v_add_f32 v137, v137, v148
  v_lshlrev_b32 v145, 16, v212
  v_mfma_f32_32x32x16_bf16 v[64:79], v[196:199], v[212:215], v[64:79]
  v_and_b32 v146, 0xffff0000, v212
  v_add_f32 v138, v138, v145
  v_add_f32 v138, v138, v146
  v_mfma_f32_32x32x16_bf16 v[80:95], v[200:203], v[212:215], v[80:95]
  s_branch Lafter_19
Lw_21:
  s_barrier
  ds_read_b64_tr_b16 v[104:105], v143 offset:0
  ds_read_b64_tr_b16 v[106:107], v143 offset:768
  ds_read_b128 v[96:99], v139 offset:0
  ds_read_b64_tr_b16 v[108:109], v143 offset:64
  ds_read_b64_tr_b16 v[110:111], v143 offset:832
  ds_read_b128 v[100:103], v139 offset:4096
  ds_read_b64_tr_b16 v[112:113], v143 offset:128
  ds_read_b64_tr_b16 v[114:115], v143 offset:896
  ds_read_b64_tr_b16 v[124:125], v143 offset:3072
  ds_read_b64_tr_b16 v[126:127], v143 offset:3840
  ds_read_b128 v[116:119], v140 offset:0
  ds_read_b64_tr_b16 v[128:129], v143 offset:3136
  ds_read_b64_tr_b16 v[130:131], v143 offset:3904
  ds_read_b128 v[120:123], v140 offset:4096
  ds_read_b64_tr_b16 v[132:133], v143 offset:3200
  ds_read_b64_tr_b16 v[134:135], v143 offset:3968
Lk1_30:
  s_waitcnt lgkmcnt(8)
  v_mfma_f32_32x32x16_bf16 v[0:15], v[104:107], v[96:99], v[0:15]
  ds_read_b64_tr_b16 v[184:185], v143 offset:6144
  ds_read_b64_tr_b16 v[186:187], v143 offset:6912
  ds_read_b128 v[176:179], v141 offset:0
  v_lshlrev_b32 v145, 16, v105
  v_and_b32 v146, 0xffff0000, v105
  v_mfma_f32_32x32x16_bf16 v[32:47], v[108:111], v[96:99], v[32:47]
  ds_read_b64_tr_b16 v[188:189], v143 offset:6208
  ds_read_b64_tr_b16 v[190:191], v143 offset:6976
  ds_read_b128 v[180:183], v141 offset:4096
  v_add_f32 v136, v136, v145
  v_add_f32 v136, v136, v146
  v_mfma_f32_32x32x16_bf16 v[16:31], v[104:107], v[100:103], v[16:31]
  ds_read_b64_tr_b16 v[192:193], v143 offset:6272
  ds_read_b64_tr_b16 v[194:195], v143 offset:7040
  v_lshlrev_b32 v147, 16, v109
  v_and_b32 v148, 0xffff0000, v109
  v_mfma_f32_32x32x16_bf16 v[48:63], v[108:111], v[100:103], v[48:63]
  v_add_f32 v137, v137, v147
  v_add_f32 v137, v137, v148
  v_lshlrev_b32 v145, 16, v113
  v_mfma_f32_32x32x16_bf16 v[64:79], v[96:99], v[112:115], v[64:79]
  v_and_b32 v146, 0xffff0000, v113
  v_add_f32 v138, v138, v145
  v_add_f32 v138, v138, v146
  v_mfma_f32_32x32x16_bf16 v[80:95], v[100:103], v[112:115], v[80:95]
  s_waitcnt lgkmcnt(8)
  v_mfma_f32_32x32x16_bf16 v[0:15], v[124:127], v[116:119], v[0:15]
  ds_read_b64_tr_b16 v[204:205], v143 offset:9216
  ds_read_b64_tr_b16 v[206:207], v143 offset:9984
  ds_read_b128 v[196:199], v142 offset:0
  v_lshlrev_b32 v145, 16, v125
  v_and_b32 v146, 0xffff0000, v125
  v_mfma_f32_32x32x16_bf16 v[32:47], v[128:131], v[116:119], v[32:47]
  ds_read_b64_tr_b16 v[208:209], v143 offset:9280
  ds_read_b64_tr_b16 v[210:211], v143 offset:10048
  ds_read_b128 v[200:203], v142 offset:4096
  v_add_f32 v136, v136, v145
  v_add_f32 v136, v136, v146
  v_mfma_f32_32x32x16_bf16 v[16:31], v[124:127], v[120:123], v[16:31]
  ds_read_b64_tr_b16 v[212:213], v143 offset:9344
  ds_read_b64_tr_b16 v[214:215], v143 offset:10112
  v_lshlrev_b32 v147, 16, v129
  v_and_b32 v148, 0xffff0000, v129
  v_mfma_f32_32x32x16_bf16 v[48:63], v[128:131], v[120:123], v[48:63]
  v_add_f32 v137, v137, v147
  v_add_f32 v137, v137, v148
  v_lshlrev_b32 v145, 16, v133
  v_mfma_f32_32x32x16_bf16 v[64:79], v[116:119], v[132:135], v[64:79]
  v_and_b32 v146, 0xffff0000, v133
  v_add_f32 v138, v138, v145
  v_add_f32 v138, v138, v146
  v_mfma_f32_32x32x16_bf16 v[80:95], v[120:123], v[132:135], v[80:95]
  s_waitcnt lgkmcnt(0)
  s_barrier
  s_add_u32 s45, s45, 32768
  s_mov_b32 s46, 32768
  s_cmp_eq_u32 s45, 98304
  s_cselect_b32 s45, 0, s45
  s_cselect_b32 s46, -65536, s46
  s_add_u32 s51, s51, 12288
  s_mov_b32 s47, 12288
  s_cmp_eq_u32 s51, 36864
  s_cselect_b32 s51, 0, s51
  s_cselect_b32 s47, -24576, s47
  v_add_u32 v139, s46, v139
  v_add_u32 v140, s46, v140
  v_add_u32 v141, s46, v141
  v_add_u32 v142, s46, v142
  v_add_u32 v143, s47, v143
  v_mfma_f32_32x32x16_bf16 v[0:15], v[184:187], v[176:179], v[0:15]
  ds_read_b64_tr_b16 v[104:105], v143 offset:0
  ds_read_b64_tr_b16 v[106:107], v143 offset:768
  ds_read_b128 v[96:99], v139 offset:0
  v_lshlrev_b32 v145, 16, v185
  v_and_b32 v146, 0xffff0000, v185
  v_mfma_f32_32x32x16_bf16 v[32:47], v[188:191], v[176:179], v[32:47]
  ds_read_b64_tr_b16 v[108:109], v143 offset:64
  ds_read_b64_tr_b16 v[110:111], v143 offset:832
  ds_read_b128 v[100:103], v139 offset:4096
  v_add_f32 v136, v136, v145
  v_add_f32 v136, v136, v146
  v_mfma_f32_32x32x16_bf16 v[16:31], v[184:187], v[180:183], v[16:31]
  ds_read_b64_tr_b16 v[112:113], v143 offset:128
  ds_read_b64_tr_b16 v[114:115], v143 offset:896
  v_lshlrev_b32 v147, 16, v189
  v_and_b32 v148, 0xffff0000, v189
  v_mfma_f32_32x32x16_bf16 v[48:63], v[188:191], v[180:183], v[48:63]
  v_add_f32 v137, v137, v147
  v_add_f32 v137, v137, v148
  v_lshlrev_b32 v145, 16, v193
  v_mfma_f32_32x32x16_bf16 v[64:79], v[176:179], v[192:195], v[64:79]
  v_and_b32 v146, 0xffff0000, v193
  v_add_f32 v138, v138, v145
  v_add_f32 v138, v138, v146
  v_mfma_f32_32x32x16_bf16 v[80:95], v[180:183], v[192:195], v[80:95]
  s_nop 0
  v_mfma_f32_32x32x16_bf16 v[0:15], v[204:207], v[196:199], v[0:15]
  ds_read_b64_tr_b16 v[124:125], v143 offset:3072
  ds_read_b64_tr_b16 v[126:127], v143 offset:3840
  ds_read_b128 v[116:119], v140 offset:0
  v_lshlrev_b32 v145, 16, v205
  v_and_b32 v146, 0xffff0000, v205
  v_mfma_f32_32x32x16_bf16 v[32:47], v[208:211], v[196:199], v[32:47]
  ds_read_b64_tr_b16 v[128:129], v143 offset:3136
  ds_read_b64_tr_b16 v[130:131], v143 offset:3904
  ds_read_b128 v[120:123], v140 offset:4096
  v_add_f32 v136, v136, v145
  v_add_f32 v136, v136, v146
  v_mfma_f32_32x32x16_bf16 v[16:31], v[204:207], v[200:203], v[16:31]
  ds_read_b64_tr_b16 v[132:133], v143 offset:3200
  ds_read_b64_tr_b16 v[134:135], v143 offset:3968
  v_lshlrev_b32 v147, 16, v209
  v_and_b32 v148, 0xffff0000, v209
  v_mfma_f32_32x32x16_bf16 v[48:63], v[208:211], v[200:203], v[48:63]
  v_add_f32 v137, v137, v147
  v_add_f32 v137, v137, v148
  v_lshlrev_b32 v145, 16, v213
  v_mfma_f32_32x32x16_bf16 v[64:79], v[196:199], v[212:215], v[64:79]
  v_and_b32 v146, 0xffff0000, v213
  v_add_f32 v138, v138, v145
  v_add_f32 v138, v138, v146
  v_mfma_f32_32x32x16_bf16 v[80:95], v[200:203], v[212:215], v[80:95]
  s_add_u32 s50, s50, 1
  s_cmp_lt_u32 s50, 15
  s_cbranch_scc1 Lk1_30
  s_waitcnt lgkmcnt(8)
  v_mfma_f32_32x32x16_bf16 v[0:15], v[104:107], v[96:99], v[0:15]
  ds_read_b64_tr_b16 v[184:185], v143 offset:6144
  ds_read_b64_tr_b16 v[186:187], v143 offset:6912
  ds_read_b128 v[176:179], v141 offset:0
  v_lshlrev_b32 v145, 16, v105
  v_and_b32 v146, 0xffff0000, v105
  v_mfma_f32_32x32x16_bf16 v[32:47], v[108:111], v[96:99], v[32:47]
  ds_read_b64_tr_b16 v[188:189], v143 offset:6208
  ds_read_b64_tr_b16 v[190:191], v143 offset:6976
  ds_read_b128 v[180:183], v141 offset:4096
  v_add_f32 v136, v136, v145
  v_add_f32 v136, v136, v146
  v_mfma_f32_32x32x16_bf16 v[16:31], v[104:107], v[100:103], v[16:31]
  ds_read_b64_tr_b16 v[192:193], v143 offset:6272
  ds_read_b64_tr_b16 v[194:195], v143 offset:7040
  v_lshlrev_b32 v147, 16, v109
  v_and_b32 v148, 0xffff0000, v109
  v_mfma_f32_32x32x16_bf16 v[48:63], v[108:111], v[100:103], v[48:63]
  v_add_f32 v137, v137, v147
  v_add_f32 v137, v137, v148
  v_lshlrev_b32 v145, 16, v113
  v_mfma_f32_32x32x16_bf16 v[64:79], v[96:99], v[112:115], v[64:79]
  v_and_b32 v146, 0xffff0000, v113
  v_add_f32 v138, v138, v145
  v_add_f32 v138, v138, v146
  v_mfma_f32_32x32x16_bf16 v[80:95], v[100:103], v[112:115], v[80:95]
  s_waitcnt lgkmcnt(8)
  v_mfma_f32_32x32x16_bf16 v[0:15], v[124:127], v[116:119], v[0:15]
  ds_read_b64_tr_b16 v[204:205], v143 offset:9216
  ds_read_b64_tr_b16 v[206:207], v143 offset:9984
  ds_read_b128 v[196:199], v142 offset:0
  v_lshlrev_b32 v145, 16, v125
  v_and_b32 v146, 0xffff0000, v125
  v_mfma_f32_32x32x16_bf16 v[32:47], v[128:131], v[116:119], v[32:47]
  ds_read_b64_tr_b16 v[208:209], v143 offset:9280
  ds_read_b64_tr_b16 v[210:211], v143 offset:10048
  ds_read_b128 v[200:203], v142 offset:4096
  v_add_f32 v136, v136, v145
  v_add_f32 v136, v136, v146
  v_mfma_f32_32x32x16_bf16 v[16:31], v[124:127], v[120:123], v[16:31]
  ds_read_b64_tr_b16 v[212:213], v143 offset:9344
  ds_read_b64_tr_b16 v[214:215], v143 offset:10112
  v_lshlrev_b32 v147, 16, v129
  v_and_b32 v148, 0xffff0000, v129
  v_mfma_f32_32x32x16_bf16 v[48:63], v[128:131], v[120:123], v[48:63]
  v_add_f32 v137, v137, v147
  v_add_f32 v137, v137, v148
  v_lshlrev_b32 v145, 16, v133
  v_mfma_f32_32x32x16_bf16 v[64:79], v[116:119], v[132:135], v[64:79]
  v_and_b32 v146, 0xffff0000, v133
  v_add_f32 v138, v138, v145
  v_add_f32 v138, v138, v146
  v_mfma_f32_32x32x16_bf16 v[80:95], v[120:123], v[132:135], v[80:95]
  s_waitcnt lgkmcnt(8)
  v_mfma_f32_32x32x16_bf16 v[0:15], v[184:187], v[176:179], v[0:15]
  v_lshlrev_b32 v145, 16, v185
  v_and_b32 v146, 0xffff0000, v185
  v_mfma_f32_32x32x16_bf16 v[32:47], v[188:191], v[176:179], v[32:47]
  v_add_f32 v136, v136, v145
  v_add_f32 v136, v136, v146
  v_mfma_f32_32x32x16_bf16 v[16:31], v[184:187], v[180:183], v[16:31]
  v_lshlrev_b32 v147, 16, v189
  v_and_b32 v148, 0xffff0000, v189
  v_mfma_f32_32x32x16_bf16 v[48:63], v[188:191], v[180:183], v[48:63]
  v_add_f32 v137, v137, v147
  v_add_f32 v137, v137, v148
  v_lshlrev_b32 v145, 16, v193
  v_mfma_f32_32x32x16_bf16 v[64:79], v[176:179], v[192:195], v[64:79]
  v_and_b32 v146, 0xffff0000, v193
  v_add_f32 v138, v138, v145
  v_add_f32 v138, v138, v146
  v_mfma_f32_32x32x16_bf16 v[80:95], v[180:183], v[192:195], v[80:95]
  s_waitcnt lgkmcnt(0)
  v_mfma_f32_32x32x16_bf16 v[0:15], v[204:207], v[196:199], v[0:15]
  v_lshlrev_b32 v145, 16, v205
  v_and_b32 v146, 0xffff0000, v205
  v_mfma_f32_32x32x16_bf16 v[32:47], v[208:211], v[196:199], v[32:47]
  v_add_f32 v136, v136, v145
  v_add_f32 v136, v136, v146
  v_mfma_f32_32x32x16_bf16 v[16:31], v[204:207], v[200:203], v[16:31]
  v_lshlrev_b32 v147, 16, v209
  v_and_b32 v148, 0xffff0000, v209
  v_mfma_f32_32x32x16_bf16 v[48:63], v[208:211], v[200:203], v[48:63]
  v_add_f32 v137, v137, v147
  v_add_f32 v137, v137, v148
  v_lshlrev_b32 v145, 16, v213
  v_mfma_f32_32x32x16_bf16 v[64:79], v[196:199], v[212:215], v[64:79]
  v_and_b32 v146, 0xffff0000, v213
  v_add_f32 v138, v138, v145
  v_add_f32 v138, v138, v146
  v_mfma_f32_32x32x16_bf16 v[80:95], v[200:203], v[212:215], v[80:95]
  s_branch Lafter_19
Lw_22:
  s_barrier
  ds_read_b64_tr_b16 v[104:105], v143 offset:0
  ds_read_b64_tr_b16 v[106:107], v143 offset:768
  ds_read_b128 v[96:99], v139 offset:0
  ds_read_b64_tr_b16 v[108:109], v143 offset:64
  ds_read_b64_tr_b16 v[110:111], v143 offset:832
  ds_read_b128 v[100:103], v139 offset:4096
  ds_read_b64_tr_b16 v[112:113], v143 offset:128
  ds_read_b64_tr_b16 v[114:115], v143 offset:896
  ds_read_b64_tr_b16 v[124:125], v143 offset:3072
  ds_read_b64_tr_b16 v[126:127], v143 offset:3840
  ds_read_b128 v[116:119], v140 offset:0
  ds_read_b64_tr_b16 v[128:129], v143 offset:3136
  ds_read_b64_tr_b16 v[130:131], v143 offset:3904
  ds_read_b128 v[120:123], v140 offset:4096
  ds_read_b64_tr_b16 v[132:133], v143 offset:3200
  ds_read_b64_tr_b16 v[134:135], v143 offset:3968
Lk1_31:
  s_waitcnt lgkmcnt(8)
  v_mfma_f32_32x32x16_bf16 v[0:15], v[104:107], v[96:99], v[0:15]
  ds_read_b64_tr_b16 v[184:185], v143 offset:6144
  ds_read_b64_tr_b16 v[186:187], v143 offset:6912
  ds_read_b128 v[176:179], v141 offset:0
  v_lshlrev_b32 v145, 16, v106
  v_and_b32 v146, 0xffff0000, v106
  v_mfma_f32_32x32x16_bf16 v[32:47], v[108:111], v[96:99], v[32:47]
  ds_read_b64_tr_b16 v[188:189], v143 offset:6208
  ds_read_b64_tr_b16 v[190:191], v143 offset:6976
  ds_read_b128 v[180:183], v141 offset:4096
  v_add_f32 v136, v136, v145
  v_add_f32 v136, v136, v146
  v_mfma_f32_32x32x16_bf16 v[16:31], v[104:107], v[100:103], v[16:31]
  ds_read_b64_tr_b16 v[192:193], v143 offset:6272
  ds_read_b64_tr_b16 v[194:195], v143 offset:7040
  v_lshlrev_b32 v147, 16, v110
  v_and_b32 v148, 0xffff0000, v110
  v_mfma_f32_32x32x16_bf16 v[48:63], v[108:111], v[100:103], v[48:63]
  v_add_f32 v137, v137, v147
  v_add_f32 v137, v137, v148
  v_lshlrev_b32 v145, 16, v114
  v_mfma_f32_32x32x16_bf16 v[64:79], v[96:99], v[112:115], v[64:79]
  v_and_b32 v146, 0xffff0000, v114
  v_add_f32 v138, v138, v145
  v_add_f32 v138, v138, v146
  v_mfma_f32_32x32x16_bf16 v[80:95], v[100:103], v[112:115], v[80:95]
  s_waitcnt lgkmcnt(8)
  v_mfma_f32_32x32x16_bf16 v[0:15], v[124:127], v[116:119], v[0:15]
  ds_read_b64_tr_b16 v[204:205], v143 offset:9216
  ds_read_b64_tr_b16 v[206:207], v143 offset:9984
  ds_read_b128 v[196:199], v142 offset:0
  v_lshlrev_b32 v145, 16, v126
  v_and_b32 v146, 0xffff0000, v126
  v_mfma_f32_32x32x16_bf16 v[32:47], v[128:131], v[116:119], v[32:47]
  ds_read_b64_tr_b16 v[208:209], v143 offset:9280
  ds_read_b64_tr_b16 v[210:211], v143 offset:10048
  ds_read_b128 v[200:203], v142 offset:4096
  v_add_f32 v136, v136, v145
  v_add_f32 v136, v136, v146
  v_mfma_f32_32x32x16_bf16 v[16:31], v[124:127], v[120:123], v[16:31]
  ds_read_b64_tr_b16 v[212:213], v143 offset:9344
  ds_read_b64_tr_b16 v[214:215], v143 offset:10112
  v_lshlrev_b32 v147, 16, v130
  v_and_b32 v148, 0xffff0000, v130
  v_mfma_f32_32x32x16_bf16 v[48:63], v[128:131], v[120:123], v[48:63]
  v_add_f32 v137, v137, v147
  v_add_f32 v137, v137, v148
  v_lshlrev_b32 v145, 16, v134
  v_mfma_f32_32x32x16_bf16 v[64:79], v[116:119], v[132:135], v[64:79]
  v_and_b32 v146, 0xffff0000, v134
  v_add_f32 v138, v138, v145
  v_add_f32 v138, v138, v146
  v_mfma_f32_32x32x16_bf16 v[80:95], v[120:123], v[132:135], v[80:95]
  s_waitcnt lgkmcnt(0)
  s_barrier
  s_add_u32 s45, s45, 32768
  s_mov_b32 s46, 32768
  s_cmp_eq_u32 s45, 98304
  s_cselect_b32 s45, 0, s45
  s_cselect_b32 s46, -65536, s46
  s_add_u32 s51, s51, 12288
  s_mov_b32 s47, 12288
  s_cmp_eq_u32 s51, 36864
  s_cselect_b32 s51, 0, s51
  s_cselect_b32 s47, -24576, s47
  v_add_u32 v139, s46, v139
  v_add_u32 v140, s46, v140
  v_add_u32 v141, s46, v141
  v_add_u32 v142, s46, v142
  v_add_u32 v143, s47, v143
  v_mfma_f32_32x32x16_bf16 v[0:15], v[184:187], v[176:179], v[0:15]
  ds_read_b64_tr_b16 v[104:105], v143 offset:0
  ds_read_b64_tr_b16 v[106:107], v143 offset:768
  ds_read_b128 v[96:99], v139 offset:0
  v_lshlrev_b32 v145, 16, v186
  v_and_b32 v146, 0xffff0000, v186
  v_mfma_f32_32x32x16_bf16 v[32:47], v[188:191], v[176:179], v[32:47]
  ds_read_b64_tr_b16 v[108:109], v143 offset:64
  ds_read_b64_tr_b16 v[110:111], v143 offset:832
  ds_read_b128 v[100:103], v139 offset:4096
  v_add_f32 v136, v136, v145
  v_add_f32 v136, v136, v146
  v_mfma_f32_32x32x16_bf16 v[16:31], v[184:187], v[180:183], v[16:31]
  ds_read_b64_tr_b16 v[112:113], v143 offset:128
  ds_read_b64_tr_b16 v[114:115], v143 offset:896
  v_lshlrev_b32 v147, 16, v190
  v_and_b32 v148, 0xffff0000, v190
  v_mfma_f32_32x32x16_bf16 v[48:63], v[188:191], v[180:183], v[48:63]
  v_add_f32 v137, v137, v147
  v_add_f32 v137, v137, v148
  v_lshlrev_b32 v145, 16, v194
  v_mfma_f32_32x32x16_bf16 v[64:79], v[176:179], v[192:195], v[64:79]
  v_and_b32 v146, 0xffff0000, v194
  v_add_f32 v138, v138, v145
  v_add_f32 v138, v138, v146
  v_mfma_f32_32x32x16_bf16 v[80:95], v[180:183], v[192:195], v[80:95]
  s_nop 0
  v_mfma_f32_32x32x16_bf16 v[0:15], v[204:207], v[196:199], v[0:15]
  ds_read_b64_tr_b16 v[124:125], v143 offset:3072
  ds_read_b64_tr_b16 v[126:127], v143 offset:3840
  ds_read_b128 v[116:119], v140 offset:0
  v_lshlrev_b32 v145, 16, v206
  v_and_b32 v146, 0xffff0000, v206
  v_mfma_f32_32x32x16_bf16 v[32:47], v[208:211], v[196:199], v[32:47]
  ds_read_b64_tr_b16 v[128:129], v143 offset:3136
  ds_read_b64_tr_b16 v[130:131], v143 offset:3904
  ds_read_b128 v[120:123], v140 offset:4096
  v_add_f32 v136, v136, v145
  v_add_f32 v136, v136, v146
  v_mfma_f32_32x32x16_bf16 v[16:31], v[204:207], v[200:203], v[16:31]
  ds_read_b64_tr_b16 v[132:133], v143 offset:3200
  ds_read_b64_tr_b16 v[134:135], v143 offset:3968
  v_lshlrev_b32 v147, 16, v210
  v_and_b32 v148, 0xffff0000, v210
  v_mfma_f32_32x32x16_bf16 v[48:63], v[208:211], v[200:203], v[48:63]
  v_add_f32 v137, v137, v147
  v_add_f32 v137, v137, v148
  v_lshlrev_b32 v145, 16, v214
  v_mfma_f32_32x32x16_bf16 v[64:79], v[196:199], v[212:215], v[64:79]
  v_and_b32 v146, 0xffff0000, v214
  v_add_f32 v138, v138, v145
  v_add_f32 v138, v138, v146
  v_mfma_f32_32x32x16_bf16 v[80:95], v[200:203], v[212:215], v[80:95]
  s_add_u32 s50, s50, 1
  s_cmp_lt_u32 s50, 15
  s_cbranch_scc1 Lk1_31
  s_waitcnt lgkmcnt(8)
  v_mfma_f32_32x32x16_bf16 v[0:15], v[104:107], v[96:99], v[0:15]
  ds_read_b64_tr_b16 v[184:185], v143 offset:6144
  ds_read_b64_tr_b16 v[186:187], v143 offset:6912
  ds_read_b128 v[176:179], v141 offset:0
  v_lshlrev_b32 v145, 16, v106
  v_and_b32 v146, 0xffff0000, v106
  v_mfma_f32_32x32x16_bf16 v[32:47], v[108:111], v[96:99], v[32:47]
  ds_read_b64_tr_b16 v[188:189], v143 offset:6208
  ds_read_b64_tr_b16 v[190:191], v143 offset:6976
  ds_read_b128 v[180:183], v141 offset:4096
  v_add_f32 v136, v136, v145
  v_add_f32 v136, v136, v146
  v_mfma_f32_32x32x16_bf16 v[16:31], v[104:107], v[100:103], v[16:31]
  ds_read_b64_tr_b16 v[192:193], v143 offset:6272
  ds_read_b64_tr_b16 v[194:195], v143 offset:7040
  v_lshlrev_b32 v147, 16, v110
  v_and_b32 v148, 0xffff0000, v110
  v_mfma_f32_32x32x16_bf16 v[48:63], v[108:111], v[100:103], v[48:63]
  v_add_f32 v137, v137, v147
  v_add_f32 v137, v137, v148
  v_lshlrev_b32 v145, 16, v114
  v_mfma_f32_32x32x16_bf16 v[64:79], v[96:99], v[112:115], v[64:79]
  v_and_b32 v146, 0xffff0000, v114
  v_add_f32 v138, v138, v145
  v_add_f32 v138, v138, v146
  v_mfma_f32_32x32x16_bf16 v[80:95], v[100:103], v[112:115], v[80:95]
  s_waitcnt lgkmcnt(8)
  v_mfma_f32_32x32x16_bf16 v[0:15], v[124:127], v[116:119], v[0:15]
  ds_read_b64_tr_b16 v[204:205], v143 offset:9216
  ds_read_b64_tr_b16 v[206:207], v143 offset:9984
  ds_read_b128 v[196:199], v142 offset:0
  v_lshlrev_b32 v145, 16, v126
  v_and_b32 v146, 0xffff0000, v126
  v_mfma_f32_32x32x16_bf16 v[32:47], v[128:131], v[116:119], v[32:47]
  ds_read_b64_tr_b16 v[208:209], v143 offset:9280
  ds_read_b64_tr_b16 v[210:211], v143 offset:10048
  ds_read_b128 v[200:203], v142 offset:4096
  v_add_f32 v136, v136, v145
  v_add_f32 v136, v136, v146
  v_mfma_f32_32x32x16_bf16 v[16:31], v[124:127], v[120:123], v[16:31]
  ds_read_b64_tr_b16 v[212:213], v143 offset:9344
  ds_read_b64_tr_b16 v[214:215], v143 offset:10112
  v_lshlrev_b32 v147, 16, v130
  v_and_b32 v148, 0xffff0000, v130
  v_mfma_f32_32x32x16_bf16 v[48:63], v[128:131], v[120:123], v[48:63]
  v_add_f32 v137, v137, v147
  v_add_f32 v137, v137, v148
  v_lshlrev_b32 v145, 16, v134
  v_mfma_f32_32x32x16_bf16 v[64:79], v[116:119], v[132:135], v[64:79]
  v_and_b32 v146, 0xffff0000, v134
  v_add_f32 v138, v138, v145
  v_add_f32 v138, v138, v146
  v_mfma_f32_32x32x16_bf16 v[80:95], v[120:123], v[132:135], v[80:95]
  s_waitcnt lgkmcnt(8)
  v_mfma_f32_32x32x16_bf16 v[0:15], v[184:187], v[176:179], v[0:15]
  v_lshlrev_b32 v145, 16, v186
  v_and_b32 v146, 0xffff0000, v186
  v_mfma_f32_32x32x16_bf16 v[32:47], v[188:191], v[176:179], v[32:47]
  v_add_f32 v136, v136, v145
  v_add_f32 v136, v136, v146
  v_mfma_f32_32x32x16_bf16 v[16:31], v[184:187], v[180:183], v[16:31]
  v_lshlrev_b32 v147, 16, v190
  v_and_b32 v148, 0xffff0000, v190
  v_mfma_f32_32x32x16_bf16 v[48:63], v[188:191], v[180:183], v[48:63]
  v_add_f32 v137, v137, v147
  v_add_f32 v137, v137, v148
  v_lshlrev_b32 v145, 16, v194
  v_mfma_f32_32x32x16_bf16 v[64:79], v[176:179], v[192:195], v[64:79]
  v_and_b32 v146, 0xffff0000, v194
  v_add_f32 v138, v138, v145
  v_add_f32 v138, v138, v146
  v_mfma_f32_32x32x16_bf16 v[80:95], v[180:183], v[192:195], v[80:95]
  s_waitcnt lgkmcnt(0)
  v_mfma_f32_32x32x16_bf16 v[0:15], v[204:207], v[196:199], v[0:15]
  v_lshlrev_b32 v145, 16, v206
  v_and_b32 v146, 0xffff0000, v206
  v_mfma_f32_32x32x16_bf16 v[32:47], v[208:211], v[196:199], v[32:47]
  v_add_f32 v136, v136, v145
  v_add_f32 v136, v136, v146
  v_mfma_f32_32x32x16_bf16 v[16:31], v[204:207], v[200:203], v[16:31]
  v_lshlrev_b32 v147, 16, v210
  v_and_b32 v148, 0xffff0000, v210
  v_mfma_f32_32x32x16_bf16 v[48:63], v[208:211], v[200:203], v[48:63]
  v_add_f32 v137, v137, v147
  v_add_f32 v137, v137, v148
  v_lshlrev_b32 v145, 16, v214
  v_mfma_f32_32x32x16_bf16 v[64:79], v[196:199], v[212:215], v[64:79]
  v_and_b32 v146, 0xffff0000, v214
  v_add_f32 v138, v138, v145
  v_add_f32 v138, v138, v146
  v_mfma_f32_32x32x16_bf16 v[80:95], v[200:203], v[212:215], v[80:95]
  s_branch Lafter_19
Lw_23:
  s_barrier
  ds_read_b64_tr_b16 v[104:105], v143 offset:0
  ds_read_b64_tr_b16 v[106:107], v143 offset:768
  ds_read_b128 v[96:99], v139 offset:0
  ds_read_b64_tr_b16 v[108:109], v143 offset:64
  ds_read_b64_tr_b16 v[110:111], v143 offset:832
  ds_read_b128 v[100:103], v139 offset:4096
  ds_read_b64_tr_b16 v[112:113], v143 offset:128
  ds_read_b64_tr_b16 v[114:115], v143 offset:896
  ds_read_b64_tr_b16 v[124:125], v143 offset:3072
  ds_read_b64_tr_b16 v[126:127], v143 offset:3840
  ds_read_b128 v[116:119], v140 offset:0
  ds_read_b64_tr_b16 v[128:129], v143 offset:3136
  ds_read_b64_tr_b16 v[130:131], v143 offset:3904
  ds_read_b128 v[120:123], v140 offset:4096
  ds_read_b64_tr_b16 v[132:133], v143 offset:3200
  ds_read_b64_tr_b16 v[134:135], v143 offset:3968
Lk1_32:
  s_waitcnt lgkmcnt(8)
  v_mfma_f32_32x32x16_bf16 v[0:15], v[104:107], v[96:99], v[0:15]
  ds_read_b64_tr_b16 v[184:185], v143 offset:6144
  ds_read_b64_tr_b16 v[186:187], v143 offset:6912
  ds_read_b128 v[176:179], v141 offset:0
  v_lshlrev_b32 v145, 16, v107
  v_and_b32 v146, 0xffff0000, v107
  v_mfma_f32_32x32x16_bf16 v[32:47], v[108:111], v[96:99], v[32:47]
  ds_read_b64_tr_b16 v[188:189], v143 offset:6208
  ds_read_b64_tr_b16 v[190:191], v143 offset:6976
  ds_read_b128 v[180:183], v141 offset:4096
  v_add_f32 v136, v136, v145
  v_add_f32 v136, v136, v146
  v_mfma_f32_32x32x16_bf16 v[16:31], v[104:107], v[100:103], v[16:31]
  ds_read_b64_tr_b16 v[192:193], v143 offset:6272
  ds_read_b64_tr_b16 v[194:195], v143 offset:7040
  v_lshlrev_b32 v147, 16, v111
  v_and_b32 v148, 0xffff0000, v111
  v_mfma_f32_32x32x16_bf16 v[48:63], v[108:111], v[100:103], v[48:63]
  v_add_f32 v137, v137, v147
  v_add_f32 v137, v137, v148
  v_lshlrev_b32 v145, 16, v115
  v_mfma_f32_32x32x16_bf16 v[64:79], v[96:99], v[112:115], v[64:79]
  v_and_b32 v146, 0xffff0000, v115
  v_add_f32 v138, v138, v145
  v_add_f32 v138, v138, v146
  v_mfma_f32_32x32x16_bf16 v[80:95], v[100:103], v[112:115], v[80:95]
  s_waitcnt lgkmcnt(8)
  v_mfma_f32_32x32x16_bf16 v[0:15], v[124:127], v[116:119], v[0:15]
  ds_read_b64_tr_b16 v[204:205], v143 offset:9216
  ds_read_b64_tr_b16 v[206:207], v143 offset:9984
  ds_read_b128 v[196:199], v142 offset:0
  v_lshlrev_b32 v145, 16, v127
  v_and_b32 v146, 0xffff0000, v127
  v_mfma_f32_32x32x16_bf16 v[32:47], v[128:131], v[116:119], v[32:47]
  ds_read_b64_tr_b16 v[208:209], v143 offset:9280
  ds_read_b64_tr_b16 v[210:211], v143 offset:10048
  ds_read_b128 v[200:203], v142 offset:4096
  v_add_f32 v136, v136, v145
  v_add_f32 v136, v136, v146
  v_mfma_f32_32x32x16_bf16 v[16:31], v[124:127], v[120:123], v[16:31]
  ds_read_b64_tr_b16 v[212:213], v143 offset:9344
  ds_read_b64_tr_b16 v[214:215], v143 offset:10112
  v_lshlrev_b32 v147, 16, v131
  v_and_b32 v148, 0xffff0000, v131
  v_mfma_f32_32x32x16_bf16 v[48:63], v[128:131], v[120:123], v[48:63]
  v_add_f32 v137, v137, v147
  v_add_f32 v137, v137, v148
  v_lshlrev_b32 v145, 16, v135
  v_mfma_f32_32x32x16_bf16 v[64:79], v[116:119], v[132:135], v[64:79]
  v_and_b32 v146, 0xffff0000, v135
  v_add_f32 v138, v138, v145
  v_add_f32 v138, v138, v146
  v_mfma_f32_32x32x16_bf16 v[80:95], v[120:123], v[132:135], v[80:95]
  s_waitcnt lgkmcnt(0)
  s_barrier
  s_add_u32 s45, s45, 32768
  s_mov_b32 s46, 32768
  s_cmp_eq_u32 s45, 98304
  s_cselect_b32 s45, 0, s45
  s_cselect_b32 s46, -65536, s46
  s_add_u32 s51, s51, 12288
  s_mov_b32 s47, 12288
  s_cmp_eq_u32 s51, 36864
  s_cselect_b32 s51, 0, s51
  s_cselect_b32 s47, -24576, s47
  v_add_u32 v139, s46, v139
  v_add_u32 v140, s46, v140
  v_add_u32 v141, s46, v141
  v_add_u32 v142, s46, v142
  v_add_u32 v143, s47, v143
  v_mfma_f32_32x32x16_bf16 v[0:15], v[184:187], v[176:179], v[0:15]
  ds_read_b64_tr_b16 v[104:105], v143 offset:0
  ds_read_b64_tr_b16 v[106:107], v143 offset:768
  ds_read_b128 v[96:99], v139 offset:0
  v_lshlrev_b32 v145, 16, v187
  v_and_b32 v146, 0xffff0000, v187
  v_mfma_f32_32x32x16_bf16 v[32:47], v[188:191], v[176:179], v[32:47]
  ds_read_b64_tr_b16 v[108:109], v143 offset:64
  ds_read_b64_tr_b16 v[110:111], v143 offset:832
  ds_read_b128 v[100:103], v139 offset:4096
  v_add_f32 v136, v136, v145
  v_add_f32 v136, v136, v146
  v_mfma_f32_32x32x16_bf16 v[16:31], v[184:187], v[180:183], v[16:31]
  ds_read_b64_tr_b16 v[112:113], v143 offset:128
  ds_read_b64_tr_b16 v[114:115], v143 offset:896
  v_lshlrev_b32 v147, 16, v191
  v_and_b32 v148, 0xffff0000, v191
  v_mfma_f32_32x32x16_bf16 v[48:63], v[188:191], v[180:183], v[48:63]
  v_add_f32 v137, v137, v147
  v_add_f32 v137, v137, v148
  v_lshlrev_b32 v145, 16, v195
  v_mfma_f32_32x32x16_bf16 v[64:79], v[176:179], v[192:195], v[64:79]
  v_and_b32 v146, 0xffff0000, v195
  v_add_f32 v138, v138, v145
  v_add_f32 v138, v138, v146
  v_mfma_f32_32x32x16_bf16 v[80:95], v[180:183], v[192:195], v[80:95]
  s_nop 0
  v_mfma_f32_32x32x16_bf16 v[0:15], v[204:207], v[196:199], v[0:15]
  ds_read_b64_tr_b16 v[124:125], v143 offset:3072
  ds_read_b64_tr_b16 v[126:127], v143 offset:3840
  ds_read_b128 v[116:119], v140 offset:0
  v_lshlrev_b32 v145, 16, v207
  v_and_b32 v146, 0xffff0000, v207
  v_mfma_f32_32x32x16_bf16 v[32:47], v[208:211], v[196:199], v[32:47]
  ds_read_b64_tr_b16 v[128:129], v143 offset:3136
  ds_read_b64_tr_b16 v[130:131], v143 offset:3904
  ds_read_b128 v[120:123], v140 offset:4096
  v_add_f32 v136, v136, v145
  v_add_f32 v136, v136, v146
  v_mfma_f32_32x32x16_bf16 v[16:31], v[204:207], v[200:203], v[16:31]
  ds_read_b64_tr_b16 v[132:133], v143 offset:3200
  ds_read_b64_tr_b16 v[134:135], v143 offset:3968
  v_lshlrev_b32 v147, 16, v211
  v_and_b32 v148, 0xffff0000, v211
  v_mfma_f32_32x32x16_bf16 v[48:63], v[208:211], v[200:203], v[48:63]
  v_add_f32 v137, v137, v147
  v_add_f32 v137, v137, v148
  v_lshlrev_b32 v145, 16, v215
  v_mfma_f32_32x32x16_bf16 v[64:79], v[196:199], v[212:215], v[64:79]
  v_and_b32 v146, 0xffff0000, v215
  v_add_f32 v138, v138, v145
  v_add_f32 v138, v138, v146
  v_mfma_f32_32x32x16_bf16 v[80:95], v[200:203], v[212:215], v[80:95]
  s_add_u32 s50, s50, 1
  s_cmp_lt_u32 s50, 15
  s_cbranch_scc1 Lk1_32
  s_waitcnt lgkmcnt(8)
  v_mfma_f32_32x32x16_bf16 v[0:15], v[104:107], v[96:99], v[0:15]
  ds_read_b64_tr_b16 v[184:185], v143 offset:6144
  ds_read_b64_tr_b16 v[186:187], v143 offset:6912
  ds_read_b128 v[176:179], v141 offset:0
  v_lshlrev_b32 v145, 16, v107
  v_and_b32 v146, 0xffff0000, v107
  v_mfma_f32_32x32x16_bf16 v[32:47], v[108:111], v[96:99], v[32:47]
  ds_read_b64_tr_b16 v[188:189], v143 offset:6208
  ds_read_b64_tr_b16 v[190:191], v143 offset:6976
  ds_read_b128 v[180:183], v141 offset:4096
  v_add_f32 v136, v136, v145
  v_add_f32 v136, v136, v146
  v_mfma_f32_32x32x16_bf16 v[16:31], v[104:107], v[100:103], v[16:31]
  ds_read_b64_tr_b16 v[192:193], v143 offset:6272
  ds_read_b64_tr_b16 v[194:195], v143 offset:7040
  v_lshlrev_b32 v147, 16, v111
  v_and_b32 v148, 0xffff0000, v111
  v_mfma_f32_32x32x16_bf16 v[48:63], v[108:111], v[100:103], v[48:63]
  v_add_f32 v137, v137, v147
  v_add_f32 v137, v137, v148
  v_lshlrev_b32 v145, 16, v115
  v_mfma_f32_32x32x16_bf16 v[64:79], v[96:99], v[112:115], v[64:79]
  v_and_b32 v146, 0xffff0000, v115
  v_add_f32 v138, v138, v145
  v_add_f32 v138, v138, v146
  v_mfma_f32_32x32x16_bf16 v[80:95], v[100:103], v[112:115], v[80:95]
  s_waitcnt lgkmcnt(8)
  v_mfma_f32_32x32x16_bf16 v[0:15], v[124:127], v[116:119], v[0:15]
  ds_read_b64_tr_b16 v[204:205], v143 offset:9216
  ds_read_b64_tr_b16 v[206:207], v143 offset:9984
  ds_read_b128 v[196:199], v142 offset:0
  v_lshlrev_b32 v145, 16, v127
  v_and_b32 v146, 0xffff0000, v127
  v_mfma_f32_32x32x16_bf16 v[32:47], v[128:131], v[116:119], v[32:47]
  ds_read_b64_tr_b16 v[208:209], v143 offset:9280
  ds_read_b64_tr_b16 v[210:211], v143 offset:10048
  ds_read_b128 v[200:203], v142 offset:4096
  v_add_f32 v136, v136, v145
  v_add_f32 v136, v136, v146
  v_mfma_f32_32x32x16_bf16 v[16:31], v[124:127], v[120:123], v[16:31]
  ds_read_b64_tr_b16 v[212:213], v143 offset:9344
  ds_read_b64_tr_b16 v[214:215], v143 offset:10112
  v_lshlrev_b32 v147, 16, v131
  v_and_b32 v148, 0xffff0000, v131
  v_mfma_f32_32x32x16_bf16 v[48:63], v[128:131], v[120:123], v[48:63]
  v_add_f32 v137, v137, v147
  v_add_f32 v137, v137, v148
  v_lshlrev_b32 v145, 16, v135
  v_mfma_f32_32x32x16_bf16 v[64:79], v[116:119], v[132:135], v[64:79]
  v_and_b32 v146, 0xffff0000, v135
  v_add_f32 v138, v138, v145
  v_add_f32 v138, v138, v146
  v_mfma_f32_32x32x16_bf16 v[80:95], v[120:123], v[132:135], v[80:95]
  s_waitcnt lgkmcnt(8)
  v_mfma_f32_32x32x16_bf16 v[0:15], v[184:187], v[176:179], v[0:15]
  v_lshlrev_b32 v145, 16, v187
  v_and_b32 v146, 0xffff0000, v187
  v_mfma_f32_32x32x16_bf16 v[32:47], v[188:191], v[176:179], v[32:47]
  v_add_f32 v136, v136, v145
  v_add_f32 v136, v136, v146
  v_mfma_f32_32x32x16_bf16 v[16:31], v[184:187], v[180:183], v[16:31]
  v_lshlrev_b32 v147, 16, v191
  v_and_b32 v148, 0xffff0000, v191
  v_mfma_f32_32x32x16_bf16 v[48:63], v[188:191], v[180:183], v[48:63]
  v_add_f32 v137, v137, v147
  v_add_f32 v137, v137, v148
  v_lshlrev_b32 v145, 16, v195
  v_mfma_f32_32x32x16_bf16 v[64:79], v[176:179], v[192:195], v[64:79]
  v_and_b32 v146, 0xffff0000, v195
  v_add_f32 v138, v138, v145
  v_add_f32 v138, v138, v146
  v_mfma_f32_32x32x16_bf16 v[80:95], v[180:183], v[192:195], v[80:95]
  s_waitcnt lgkmcnt(0)
  v_mfma_f32_32x32x16_bf16 v[0:15], v[204:207], v[196:199], v[0:15]
  v_lshlrev_b32 v145, 16, v207
  v_and_b32 v146, 0xffff0000, v207
  v_mfma_f32_32x32x16_bf16 v[32:47], v[208:211], v[196:199], v[32:47]
  v_add_f32 v136, v136, v145
  v_add_f32 v136, v136, v146
  v_mfma_f32_32x32x16_bf16 v[16:31], v[204:207], v[200:203], v[16:31]
  v_lshlrev_b32 v147, 16, v211
  v_and_b32 v148, 0xffff0000, v211
  v_mfma_f32_32x32x16_bf16 v[48:63], v[208:211], v[200:203], v[48:63]
  v_add_f32 v137, v137, v147
  v_add_f32 v137, v137, v148
  v_lshlrev_b32 v145, 16, v215
  v_mfma_f32_32x32x16_bf16 v[64:79], v[196:199], v[212:215], v[64:79]
  v_and_b32 v146, 0xffff0000, v215
  v_add_f32 v138, v138, v145
  v_add_f32 v138, v138, v146
  v_mfma_f32_32x32x16_bf16 v[80:95], v[200:203], v[212:215], v[80:95]
Lafter_19:
  v_mov_b32 v146, v136
  v_mov_b32 v147, v137
  v_mov_b32 v148, v138
  s_nop 1
  v_permlane32_swap_b32 v146, v136
  v_permlane32_swap_b32 v147, v137
  v_permlane32_swap_b32 v148, v138
  v_add_f32 v136, v136, v146
  v_add_f32 v137, v137, v147
  v_add_f32 v138, v138, v148
  v_and_b32 v145, 31, v144
  v_lshlrev_b32 v145, 2, v145
  v_add_u32 v145, 137216, v145
  s_mul_i32 s52, s40, 384
  v_add_u32 v146, s52, v145
  ds_write_b32 v146, v136 offset:0
  ds_write_b32 v146, v137 offset:128
  ds_write_b32 v146, v138 offset:256
  s_waitcnt lgkmcnt(0)
  s_barrier
  v_lshrrev_b32 v152, 5, v144
  ds_read_b32 v180, v145 offset:0
  ds_read_b32 v181, v145 offset:128
  ds_read_b32 v182, v145 offset:256
  ds_read_b32 v183, v145 offset:384
  ds_read_b32 v184, v145 offset:512
  ds_read_b32 v185, v145 offset:640
  ds_read_b32 v186, v145 offset:768
  ds_read_b32 v187, v145 offset:896
  ds_read_b32 v188, v145 offset:1024
  ds_read_b32 v189, v145 offset:1152
  ds_read_b32 v190, v145 offset:1280
  ds_read_b32 v191, v145 offset:1408
  s_waitcnt lgkmcnt(0)
  v_add_f32 v180, v180, v183
  v_add_f32 v186, v186, v189
  v_add_f32 v180, v180, v186
  v_add_f32 v181, v181, v184
  v_add_f32 v187, v187, v190
  v_add_f32 v181, v181, v187
  v_add_f32 v182, v182, v185
  v_add_f32 v188, v188, v191
  v_add_f32 v182, v182, v188
  v_mov_b32 v136, v182
  v_add_u32 v146, 1536, v146
  ds_write_b32 v146, v180
  ds_write_b32 v146, v181 offset:128
  v_lshlrev_b32 v146, 4, v152
  s_add_u32 s52, s52, 138752
  v_add_u32 v146, s52, v146
  s_waitcnt lgkmcnt(0)
  ds_read_b128 v[96:99], v146 offset:0
  ds_read_b128 v[112:115], v146 offset:128
  ds_read_b128 v[100:103], v146 offset:32
  ds_read_b128 v[116:119], v146 offset:160
  ds_read_b128 v[104:107], v146 offset:64
  ds_read_b128 v[120:123], v146 offset:192
  ds_read_b128 v[108:111], v146 offset:96
  ds_read_b128 v[124:127], v146 offset:224
  v_mov_b32 v156, 142336
  ds_read_b64 v[154:155], v156
  v_and_b32 v147, 31, v144
  s_lshl_b32 s52, s40, 6
  v_add_u32 v147, s52, v147
  v_lshlrev_b32 v147, 2, v147
  v_add_u32 v147, 140288, v147
  ds_read_b32 v128, v147 offset:0
  ds_read_b32 v132, v147 offset:1024
  ds_read_b32 v130, v147 offset:128
  ds_read_b32 v134, v147 offset:1152
  v_lshrrev_b32 v148, 4, v144
  v_and_b32 v149, 15, v144
  v_lshrrev_b32 v150, 2, v149
  v_lshrrev_b32 v151, 1, v148
  v_lshl_add_u32 v150, v151, 2, v150
  v_mov_b32 v235, v150
  v_lshlrev_b32 v150, 6, v150
  v_and_b32 v148, 1, v148
  v_lshlrev_b32 v148, 5, v148
  v_and_b32 v149, 3, v149
  v_lshl_add_u32 v148, v149, 3, v148
  v_add_u32 v150, v150, v148
  v_add_u32 v150, 135168, v150
  ds_read_b64_tr_b16 v[164:165], v150 offset:0
  ds_read_b64_tr_b16 v[166:167], v150 offset:512
  ds_read_b64_tr_b16 v[168:169], v150 offset:1024
  ds_read_b64_tr_b16 v[170:171], v150 offset:1536
  s_mul_i32 s52, s40, 9216
  s_add_u32 s52, s52, 0
  v_and_b32 v147, 31, v144
  v_mul_u32_u24 v147, 144, v147
  v_lshl_add_u32 v147, v152, 3, v147
  v_add_u32 v160, s52, v147
  v_mul_u32_u24 v147, 144, v235
  v_add_u32 v147, v147, v148
  v_add_u32 v161, s52, v147
  s_lshl_b32 s52, s40, 8
  v_lshlrev_b32 v147, 4, v152
  v_add_u32 v147, s52, v147
  v_add_u32 v162, 140288, v147
  s_waitcnt lgkmcnt(0)
  v_pk_mul_f32 v[32:33], v[32:33], v[128:129] op_sel_hi:[1,0]
  v_pk_fma_f32 v[32:33], v[112:113], v[132:133], v[32:33] op_sel_hi:[1,0,1]
  v_cvt_pk_bf16_f32 v172, v32, v33
  v_pk_mul_f32 v[34:35], v[34:35], v[128:129] op_sel_hi:[1,0]
  v_pk_fma_f32 v[34:35], v[114:115], v[132:133], v[34:35] op_sel_hi:[1,0,1]
  v_cvt_pk_bf16_f32 v173, v34, v35
  v_pk_mul_f32 v[36:37], v[36:37], v[128:129] op_sel_hi:[1,0]
  v_pk_fma_f32 v[36:37], v[116:117], v[132:133], v[36:37] op_sel_hi:[1,0,1]
  v_cvt_pk_bf16_f32 v174, v36, v37
  v_pk_mul_f32 v[38:39], v[38:39], v[128:129] op_sel_hi:[1,0]
  v_pk_fma_f32 v[38:39], v[118:119], v[132:133], v[38:39] op_sel_hi:[1,0,1]
  v_cvt_pk_bf16_f32 v175, v38, v39
  v_pk_mul_f32 v[40:41], v[40:41], v[128:129] op_sel_hi:[1,0]
  v_pk_fma_f32 v[40:41], v[120:121], v[132:133], v[40:41] op_sel_hi:[1,0,1]
  v_cvt_pk_bf16_f32 v176, v40, v41
  v_pk_mul_f32 v[42:43], v[42:43], v[128:129] op_sel_hi:[1,0]
  v_pk_fma_f32 v[42:43], v[122:123], v[132:133], v[42:43] op_sel_hi:[1,0,1]
  v_cvt_pk_bf16_f32 v177, v42, v43
  v_pk_mul_f32 v[44:45], v[44:45], v[128:129] op_sel_hi:[1,0]
  v_pk_fma_f32 v[44:45], v[124:125], v[132:133], v[44:45] op_sel_hi:[1,0,1]
  v_cvt_pk_bf16_f32 v178, v44, v45
  v_pk_mul_f32 v[46:47], v[46:47], v[128:129] op_sel_hi:[1,0]
  v_pk_fma_f32 v[46:47], v[126:127], v[132:133], v[46:47] op_sel_hi:[1,0,1]
  v_cvt_pk_bf16_f32 v179, v46, v47
  s_nop 1
  v_mfma_f32_32x32x16_bf16 v[180:195], v[164:167], v[172:175], 0
  v_mfma_f32_32x32x16_bf16 v[180:195], v[168:171], v[176:179], v[180:195]
  s_nop 7
  s_nop 4
  v_max3_f32 v228, v180, v181, v182
  v_min3_f32 v229, v180, v181, v182
  v_max3_f32 v228, v228, v183, v184
  v_min3_f32 v229, v229, v183, v184
  v_max3_f32 v228, v228, v185, v186
  v_min3_f32 v229, v229, v185, v186
  v_max3_f32 v228, v228, v187, v188
  v_min3_f32 v229, v229, v187, v188
  v_max3_f32 v228, v228, v189, v190
  v_min3_f32 v229, v229, v189, v190
  v_max3_f32 v228, v228, v191, v192
  v_min3_f32 v229, v229, v191, v192
  v_max3_f32 v228, v228, v193, v194
  v_min3_f32 v229, v229, v193, v194
  v_max_f32 v228, v228, v195
  v_min_f32 v229, v229, v195
  v_mov_b32 v230, v228
  v_mov_b32 v231, v229
  s_nop 1
  v_permlane32_swap_b32 v230, v228
  v_permlane32_swap_b32 v231, v229
  v_max_f32 v228, v228, v230
  v_min_f32 v229, v229, v231
  v_mul_f32 v228, s56, v228
  v_mul_f32 v229, s56, v229
  v_mov_b32 v232, v229
  v_pk_fma_f32 v[196:197], v[180:181], s[56:57], v[228:229] op_sel_hi:[1,0,0] neg_lo:[0,0,1] neg_hi:[0,0,1]
  v_pk_fma_f32 v[198:199], v[182:183], s[56:57], v[228:229] op_sel_hi:[1,0,0] neg_lo:[0,0,1] neg_hi:[0,0,1]
  v_pk_fma_f32 v[200:201], v[184:185], s[56:57], v[228:229] op_sel_hi:[1,0,0] neg_lo:[0,0,1] neg_hi:[0,0,1]
  v_pk_fma_f32 v[202:203], v[186:187], s[56:57], v[228:229] op_sel_hi:[1,0,0] neg_lo:[0,0,1] neg_hi:[0,0,1]
  v_pk_fma_f32 v[204:205], v[188:189], s[56:57], v[228:229] op_sel_hi:[1,0,0] neg_lo:[0,0,1] neg_hi:[0,0,1]
  v_pk_fma_f32 v[206:207], v[190:191], s[56:57], v[228:229] op_sel_hi:[1,0,0] neg_lo:[0,0,1] neg_hi:[0,0,1]
  v_pk_fma_f32 v[208:209], v[192:193], s[56:57], v[228:229] op_sel_hi:[1,0,0] neg_lo:[0,0,1] neg_hi:[0,0,1]
  v_pk_fma_f32 v[210:211], v[194:195], s[56:57], v[228:229] op_sel_hi:[1,0,0] neg_lo:[0,0,1] neg_hi:[0,0,1]
  v_exp_f32 v196, v196
  v_exp_f32 v197, v197
  v_exp_f32 v198, v198
  v_exp_f32 v199, v199
  v_exp_f32 v200, v200
  v_exp_f32 v201, v201
  v_exp_f32 v202, v202
  v_exp_f32 v203, v203
  v_exp_f32 v204, v204
  v_exp_f32 v205, v205
  v_exp_f32 v206, v206
  v_exp_f32 v207, v207
  v_exp_f32 v208, v208
  v_exp_f32 v209, v209
  v_exp_f32 v210, v210
  v_exp_f32 v211, v211
  s_nop 0
  v_pk_add_f32 v[230:231], v[196:197], v[198:199]
  v_pk_add_f32 v[234:235], v[200:201], v[202:203]
  v_pk_add_f32 v[230:231], v[230:231], v[204:205]
  v_pk_add_f32 v[234:235], v[234:235], v[206:207]
  v_pk_add_f32 v[230:231], v[230:231], v[208:209]
  v_pk_add_f32 v[234:235], v[234:235], v[210:211]
  v_pk_add_f32 v[230:231], v[230:231], v[234:235]
  v_add_f32 v230, v230, v231
  v_mov_b32 v231, v230
  s_nop 1
  v_permlane32_swap_b32 v231, v230
  v_add_f32 v230, v230, v231
  v_rcp_f32 v234, v230
  s_nop 0
  v_pk_mul_f32 v[196:197], v[196:197], v[234:235] op_sel_hi:[1,0]
  v_cvt_pk_bf16_f32 v212, v196, v197
  v_pk_mul_f32 v[198:199], v[198:199], v[234:235] op_sel_hi:[1,0]
  v_cvt_pk_bf16_f32 v213, v198, v199
  v_pk_mul_f32 v[200:201], v[200:201], v[234:235] op_sel_hi:[1,0]
  v_cvt_pk_bf16_f32 v214, v200, v201
  v_pk_mul_f32 v[202:203], v[202:203], v[234:235] op_sel_hi:[1,0]
  v_cvt_pk_bf16_f32 v215, v202, v203
  v_pk_mul_f32 v[204:205], v[204:205], v[234:235] op_sel_hi:[1,0]
  v_cvt_pk_bf16_f32 v216, v204, v205
  v_pk_mul_f32 v[206:207], v[206:207], v[234:235] op_sel_hi:[1,0]
  v_cvt_pk_bf16_f32 v217, v206, v207
  v_pk_mul_f32 v[208:209], v[208:209], v[234:235] op_sel_hi:[1,0]
  v_cvt_pk_bf16_f32 v218, v208, v209
  v_pk_mul_f32 v[210:211], v[210:211], v[234:235] op_sel_hi:[1,0]
  v_cvt_pk_bf16_f32 v219, v210, v211
  v_pk_fma_f32 v[196:197], v[180:181], s[56:57], v[232:233] op_sel_hi:[1,0,0] neg_lo:[1,0,0] neg_hi:[1,0,0]
  v_pk_fma_f32 v[198:199], v[182:183], s[56:57], v[232:233] op_sel_hi:[1,0,0] neg_lo:[1,0,0] neg_hi:[1,0,0]
  v_pk_fma_f32 v[200:201], v[184:185], s[56:57], v[232:233] op_sel_hi:[1,0,0] neg_lo:[1,0,0] neg_hi:[1,0,0]
  v_pk_fma_f32 v[202:203], v[186:187], s[56:57], v[232:233] op_sel_hi:[1,0,0] neg_lo:[1,0,0] neg_hi:[1,0,0]
  v_pk_fma_f32 v[204:205], v[188:189], s[56:57], v[232:233] op_sel_hi:[1,0,0] neg_lo:[1,0,0] neg_hi:[1,0,0]
  v_pk_fma_f32 v[206:207], v[190:191], s[56:57], v[232:233] op_sel_hi:[1,0,0] neg_lo:[1,0,0] neg_hi:[1,0,0]
  v_pk_fma_f32 v[208:209], v[192:193], s[56:57], v[232:233] op_sel_hi:[1,0,0] neg_lo:[1,0,0] neg_hi:[1,0,0]
  v_pk_fma_f32 v[210:211], v[194:195], s[56:57], v[232:233] op_sel_hi:[1,0,0] neg_lo:[1,0,0] neg_hi:[1,0,0]
  v_exp_f32 v196, v196
  v_exp_f32 v197, v197
  v_exp_f32 v198, v198
  v_exp_f32 v199, v199
  v_exp_f32 v200, v200
  v_exp_f32 v201, v201
  v_exp_f32 v202, v202
  v_exp_f32 v203, v203
  v_exp_f32 v204, v204
  v_exp_f32 v205, v205
  v_exp_f32 v206, v206
  v_exp_f32 v207, v207
  v_exp_f32 v208, v208
  v_exp_f32 v209, v209
  v_exp_f32 v210, v210
  v_exp_f32 v211, v211
  s_nop 0
  v_pk_add_f32 v[230:231], v[196:197], v[198:199]
  v_pk_add_f32 v[234:235], v[200:201], v[202:203]
  v_pk_add_f32 v[230:231], v[230:231], v[204:205]
  v_pk_add_f32 v[234:235], v[234:235], v[206:207]
  v_pk_add_f32 v[230:231], v[230:231], v[208:209]
  v_pk_add_f32 v[234:235], v[234:235], v[210:211]
  v_pk_add_f32 v[230:231], v[230:231], v[234:235]
  v_add_f32 v230, v230, v231
  v_mov_b32 v231, v230
  s_nop 1
  v_permlane32_swap_b32 v231, v230
  v_add_f32 v230, v230, v231
  v_rcp_f32 v234, v230
  s_nop 0
  v_pk_mul_f32 v[196:197], v[196:197], v[234:235] op_sel_hi:[1,0]
  v_cvt_pk_bf16_f32 v220, v196, v197
  v_pk_mul_f32 v[198:199], v[198:199], v[234:235] op_sel_hi:[1,0]
  v_cvt_pk_bf16_f32 v221, v198, v199
  v_pk_mul_f32 v[200:201], v[200:201], v[234:235] op_sel_hi:[1,0]
  v_cvt_pk_bf16_f32 v222, v200, v201
  v_pk_mul_f32 v[202:203], v[202:203], v[234:235] op_sel_hi:[1,0]
  v_cvt_pk_bf16_f32 v223, v202, v203
  v_pk_mul_f32 v[204:205], v[204:205], v[234:235] op_sel_hi:[1,0]
  v_cvt_pk_bf16_f32 v224, v204, v205
  v_pk_mul_f32 v[206:207], v[206:207], v[234:235] op_sel_hi:[1,0]
  v_cvt_pk_bf16_f32 v225, v206, v207
  v_pk_mul_f32 v[208:209], v[208:209], v[234:235] op_sel_hi:[1,0]
  v_cvt_pk_bf16_f32 v226, v208, v209
  v_pk_mul_f32 v[210:211], v[210:211], v[234:235] op_sel_hi:[1,0]
  v_cvt_pk_bf16_f32 v227, v210, v211
  ds_write_b64 v160, v[212:213] offset:0
  ds_write_b64 v160, v[220:221] offset:64
  ds_write_b64 v160, v[214:215] offset:16
  ds_write_b64 v160, v[222:223] offset:80
  ds_write_b64 v160, v[216:217] offset:32
  ds_write_b64 v160, v[224:225] offset:96
  ds_write_b64 v160, v[218:219] offset:48
  ds_write_b64 v160, v[226:227] offset:112
  v_pk_mul_f32 v[48:49], v[48:49], v[130:131] op_sel_hi:[1,0]
  v_pk_fma_f32 v[48:49], v[112:113], v[134:135], v[48:49] op_sel_hi:[1,0,1]
  v_cvt_pk_bf16_f32 v172, v48, v49
  v_pk_mul_f32 v[50:51], v[50:51], v[130:131] op_sel_hi:[1,0]
  v_pk_fma_f32 v[50:51], v[114:115], v[134:135], v[50:51] op_sel_hi:[1,0,1]
  v_cvt_pk_bf16_f32 v173, v50, v51
  v_pk_mul_f32 v[52:53], v[52:53], v[130:131] op_sel_hi:[1,0]
  v_pk_fma_f32 v[52:53], v[116:117], v[134:135], v[52:53] op_sel_hi:[1,0,1]
  v_cvt_pk_bf16_f32 v174, v52, v53
  v_pk_mul_f32 v[54:55], v[54:55], v[130:131] op_sel_hi:[1,0]
  v_pk_fma_f32 v[54:55], v[118:119], v[134:135], v[54:55] op_sel_hi:[1,0,1]
  v_cvt_pk_bf16_f32 v175, v54, v55
  v_pk_mul_f32 v[56:57], v[56:57], v[130:131] op_sel_hi:[1,0]
  v_pk_fma_f32 v[56:57], v[120:121], v[134:135], v[56:57] op_sel_hi:[1,0,1]
  v_cvt_pk_bf16_f32 v176, v56, v57
  v_pk_mul_f32 v[58:59], v[58:59], v[130:131] op_sel_hi:[1,0]
  v_pk_fma_f32 v[58:59], v[122:123], v[134:135], v[58:59] op_sel_hi:[1,0,1]
  v_cvt_pk_bf16_f32 v177, v58, v59
  v_pk_mul_f32 v[60:61], v[60:61], v[130:131] op_sel_hi:[1,0]
  v_pk_fma_f32 v[60:61], v[124:125], v[134:135], v[60:61] op_sel_hi:[1,0,1]
  v_cvt_pk_bf16_f32 v178, v60, v61
  v_pk_mul_f32 v[62:63], v[62:63], v[130:131] op_sel_hi:[1,0]
  v_pk_fma_f32 v[62:63], v[126:127], v[134:135], v[62:63] op_sel_hi:[1,0,1]
  v_cvt_pk_bf16_f32 v179, v62, v63
  s_nop 1
  v_mfma_f32_32x32x16_bf16 v[180:195], v[164:167], v[172:175], 0
  v_mfma_f32_32x32x16_bf16 v[180:195], v[168:171], v[176:179], v[180:195]
  s_nop 7
  s_nop 4
  v_max3_f32 v228, v180, v181, v182
  v_min3_f32 v229, v180, v181, v182
  v_max3_f32 v228, v228, v183, v184
  v_min3_f32 v229, v229, v183, v184
  v_max3_f32 v228, v228, v185, v186
  v_min3_f32 v229, v229, v185, v186
  v_max3_f32 v228, v228, v187, v188
  v_min3_f32 v229, v229, v187, v188
  v_max3_f32 v228, v228, v189, v190
  v_min3_f32 v229, v229, v189, v190
  v_max3_f32 v228, v228, v191, v192
  v_min3_f32 v229, v229, v191, v192
  v_max3_f32 v228, v228, v193, v194
  v_min3_f32 v229, v229, v193, v194
  v_max_f32 v228, v228, v195
  v_min_f32 v229, v229, v195
  v_mov_b32 v230, v228
  v_mov_b32 v231, v229
  s_nop 1
  v_permlane32_swap_b32 v230, v228
  v_permlane32_swap_b32 v231, v229
  v_max_f32 v228, v228, v230
  v_min_f32 v229, v229, v231
  v_mul_f32 v228, s56, v228
  v_mul_f32 v229, s56, v229
  v_mov_b32 v232, v229
  v_pk_fma_f32 v[196:197], v[180:181], s[56:57], v[228:229] op_sel_hi:[1,0,0] neg_lo:[0,0,1] neg_hi:[0,0,1]
  v_pk_fma_f32 v[198:199], v[182:183], s[56:57], v[228:229] op_sel_hi:[1,0,0] neg_lo:[0,0,1] neg_hi:[0,0,1]
  v_pk_fma_f32 v[200:201], v[184:185], s[56:57], v[228:229] op_sel_hi:[1,0,0] neg_lo:[0,0,1] neg_hi:[0,0,1]
  v_pk_fma_f32 v[202:203], v[186:187], s[56:57], v[228:229] op_sel_hi:[1,0,0] neg_lo:[0,0,1] neg_hi:[0,0,1]
  v_pk_fma_f32 v[204:205], v[188:189], s[56:57], v[228:229] op_sel_hi:[1,0,0] neg_lo:[0,0,1] neg_hi:[0,0,1]
  v_pk_fma_f32 v[206:207], v[190:191], s[56:57], v[228:229] op_sel_hi:[1,0,0] neg_lo:[0,0,1] neg_hi:[0,0,1]
  v_pk_fma_f32 v[208:209], v[192:193], s[56:57], v[228:229] op_sel_hi:[1,0,0] neg_lo:[0,0,1] neg_hi:[0,0,1]
  v_pk_fma_f32 v[210:211], v[194:195], s[56:57], v[228:229] op_sel_hi:[1,0,0] neg_lo:[0,0,1] neg_hi:[0,0,1]
  v_exp_f32 v196, v196
  v_exp_f32 v197, v197
  v_exp_f32 v198, v198
  v_exp_f32 v199, v199
  v_exp_f32 v200, v200
  v_exp_f32 v201, v201
  v_exp_f32 v202, v202
  v_exp_f32 v203, v203
  v_exp_f32 v204, v204
  v_exp_f32 v205, v205
  v_exp_f32 v206, v206
  v_exp_f32 v207, v207
  v_exp_f32 v208, v208
  v_exp_f32 v209, v209
  v_exp_f32 v210, v210
  v_exp_f32 v211, v211
  s_nop 0
  v_pk_add_f32 v[230:231], v[196:197], v[198:199]
  v_pk_add_f32 v[234:235], v[200:201], v[202:203]
  v_pk_add_f32 v[230:231], v[230:231], v[204:205]
  v_pk_add_f32 v[234:235], v[234:235], v[206:207]
  v_pk_add_f32 v[230:231], v[230:231], v[208:209]
  v_pk_add_f32 v[234:235], v[234:235], v[210:211]
  v_pk_add_f32 v[230:231], v[230:231], v[234:235]
  v_add_f32 v230, v230, v231
  v_mov_b32 v231, v230
  s_nop 1
  v_permlane32_swap_b32 v231, v230
  v_add_f32 v230, v230, v231
  v_rcp_f32 v234, v230
  s_nop 0
  v_pk_mul_f32 v[196:197], v[196:197], v[234:235] op_sel_hi:[1,0]
  v_cvt_pk_bf16_f32 v212, v196, v197
  v_pk_mul_f32 v[198:199], v[198:199], v[234:235] op_sel_hi:[1,0]
  v_cvt_pk_bf16_f32 v213, v198, v199
  v_pk_mul_f32 v[200:201], v[200:201], v[234:235] op_sel_hi:[1,0]
  v_cvt_pk_bf16_f32 v214, v200, v201
  v_pk_mul_f32 v[202:203], v[202:203], v[234:235] op_sel_hi:[1,0]
  v_cvt_pk_bf16_f32 v215, v202, v203
  v_pk_mul_f32 v[204:205], v[204:205], v[234:235] op_sel_hi:[1,0]
  v_cvt_pk_bf16_f32 v216, v204, v205
  v_pk_mul_f32 v[206:207], v[206:207], v[234:235] op_sel_hi:[1,0]
  v_cvt_pk_bf16_f32 v217, v206, v207
  v_pk_mul_f32 v[208:209], v[208:209], v[234:235] op_sel_hi:[1,0]
  v_cvt_pk_bf16_f32 v218, v208, v209
  v_pk_mul_f32 v[210:211], v[210:211], v[234:235] op_sel_hi:[1,0]
  v_cvt_pk_bf16_f32 v219, v210, v211
  v_pk_fma_f32 v[196:197], v[180:181], s[56:57], v[232:233] op_sel_hi:[1,0,0] neg_lo:[1,0,0] neg_hi:[1,0,0]
  v_pk_fma_f32 v[198:199], v[182:183], s[56:57], v[232:233] op_sel_hi:[1,0,0] neg_lo:[1,0,0] neg_hi:[1,0,0]
  v_pk_fma_f32 v[200:201], v[184:185], s[56:57], v[232:233] op_sel_hi:[1,0,0] neg_lo:[1,0,0] neg_hi:[1,0,0]
  v_pk_fma_f32 v[202:203], v[186:187], s[56:57], v[232:233] op_sel_hi:[1,0,0] neg_lo:[1,0,0] neg_hi:[1,0,0]
  v_pk_fma_f32 v[204:205], v[188:189], s[56:57], v[232:233] op_sel_hi:[1,0,0] neg_lo:[1,0,0] neg_hi:[1,0,0]
  v_pk_fma_f32 v[206:207], v[190:191], s[56:57], v[232:233] op_sel_hi:[1,0,0] neg_lo:[1,0,0] neg_hi:[1,0,0]
  v_pk_fma_f32 v[208:209], v[192:193], s[56:57], v[232:233] op_sel_hi:[1,0,0] neg_lo:[1,0,0] neg_hi:[1,0,0]
  v_pk_fma_f32 v[210:211], v[194:195], s[56:57], v[232:233] op_sel_hi:[1,0,0] neg_lo:[1,0,0] neg_hi:[1,0,0]
  v_exp_f32 v196, v196
  v_exp_f32 v197, v197
  v_exp_f32 v198, v198
  v_exp_f32 v199, v199
  v_exp_f32 v200, v200
  v_exp_f32 v201, v201
  v_exp_f32 v202, v202
  v_exp_f32 v203, v203
  v_exp_f32 v204, v204
  v_exp_f32 v205, v205
  v_exp_f32 v206, v206
  v_exp_f32 v207, v207
  v_exp_f32 v208, v208
  v_exp_f32 v209, v209
  v_exp_f32 v210, v210
  v_exp_f32 v211, v211
  s_nop 0
  v_pk_add_f32 v[230:231], v[196:197], v[198:199]
  v_pk_add_f32 v[234:235], v[200:201], v[202:203]
  v_pk_add_f32 v[230:231], v[230:231], v[204:205]
  v_pk_add_f32 v[234:235], v[234:235], v[206:207]
  v_pk_add_f32 v[230:231], v[230:231], v[208:209]
  v_pk_add_f32 v[234:235], v[234:235], v[210:211]
  v_pk_add_f32 v[230:231], v[230:231], v[234:235]
  v_add_f32 v230, v230, v231
  v_mov_b32 v231, v230
  s_nop 1
  v_permlane32_swap_b32 v231, v230
  v_add_f32 v230, v230, v231
  v_rcp_f32 v234, v230
  s_nop 0
  v_pk_mul_f32 v[196:197], v[196:197], v[234:235] op_sel_hi:[1,0]
  v_cvt_pk_bf16_f32 v220, v196, v197
  v_pk_mul_f32 v[198:199], v[198:199], v[234:235] op_sel_hi:[1,0]
  v_cvt_pk_bf16_f32 v221, v198, v199
  v_pk_mul_f32 v[200:201], v[200:201], v[234:235] op_sel_hi:[1,0]
  v_cvt_pk_bf16_f32 v222, v200, v201
  v_pk_mul_f32 v[202:203], v[202:203], v[234:235] op_sel_hi:[1,0]
  v_cvt_pk_bf16_f32 v223, v202, v203
  v_pk_mul_f32 v[204:205], v[204:205], v[234:235] op_sel_hi:[1,0]
  v_cvt_pk_bf16_f32 v224, v204, v205
  v_pk_mul_f32 v[206:207], v[206:207], v[234:235] op_sel_hi:[1,0]
  v_cvt_pk_bf16_f32 v225, v206, v207
  v_pk_mul_f32 v[208:209], v[208:209], v[234:235] op_sel_hi:[1,0]
  v_cvt_pk_bf16_f32 v226, v208, v209
  v_pk_mul_f32 v[210:211], v[210:211], v[234:235] op_sel_hi:[1,0]
  v_cvt_pk_bf16_f32 v227, v210, v211
  ds_write_b64 v160, v[212:213] offset:4608
  ds_write_b64 v160, v[220:221] offset:4672
  ds_write_b64 v160, v[214:215] offset:4624
  ds_write_b64 v160, v[222:223] offset:4688
  ds_write_b64 v160, v[216:217] offset:4640
  ds_write_b64 v160, v[224:225] offset:4704
  ds_write_b64 v160, v[218:219] offset:4656
  ds_write_b64 v160, v[226:227] offset:4720
  v_mov_b32 v252, s57
  v_mov_b32 v253, s57
  v_mov_b32 v254, s57
  v_mov_b32 v255, s57
  s_waitcnt lgkmcnt(0)
  ds_read_b128 v[228:231], v162 offset:0
  ds_read_b128 v[112:115], v162 offset:1024
  ds_read_b128 v[232:235], v162 offset:32
  ds_read_b128 v[116:119], v162 offset:1056
  ds_read_b128 v[236:239], v162 offset:64
  ds_read_b128 v[120:123], v162 offset:1088
  ds_read_b128 v[240:243], v162 offset:96
  ds_read_b128 v[124:127], v162 offset:1120
  ds_read_b64_tr_b16 v[212:213], v161 offset:0
  ds_read_b64_tr_b16 v[214:215], v161 offset:1152
  ds_read_b64_tr_b16 v[216:217], v161 offset:2304
  ds_read_b64_tr_b16 v[218:219], v161 offset:3456
  ds_read_b64_tr_b16 v[220:221], v161 offset:64
  ds_read_b64_tr_b16 v[222:223], v161 offset:1216
  ds_read_b64_tr_b16 v[224:225], v161 offset:2368
  ds_read_b64_tr_b16 v[226:227], v161 offset:3520
  s_waitcnt lgkmcnt(8)
  v_pk_mul_f32 v[64:65], v[64:65], v[228:229]
  v_pk_fma_f32 v[64:65], v[112:113], v[136:137], v[64:65] op_sel_hi:[1,0,1]
  v_cvt_pk_bf16_f32 v244, v64, v65
  v_pk_mul_f32 v[66:67], v[66:67], v[230:231]
  v_pk_fma_f32 v[66:67], v[114:115], v[136:137], v[66:67] op_sel_hi:[1,0,1]
  v_cvt_pk_bf16_f32 v245, v66, v67
  v_pk_mul_f32 v[68:69], v[68:69], v[232:233]
  v_pk_fma_f32 v[68:69], v[116:117], v[136:137], v[68:69] op_sel_hi:[1,0,1]
  v_cvt_pk_bf16_f32 v246, v68, v69
  v_pk_mul_f32 v[70:71], v[70:71], v[234:235]
  v_pk_fma_f32 v[70:71], v[118:119], v[136:137], v[70:71] op_sel_hi:[1,0,1]
  v_cvt_pk_bf16_f32 v247, v70, v71
  v_pk_mul_f32 v[72:73], v[72:73], v[236:237]
  v_pk_fma_f32 v[72:73], v[120:121], v[136:137], v[72:73] op_sel_hi:[1,0,1]
  v_cvt_pk_bf16_f32 v248, v72, v73
  v_pk_mul_f32 v[74:75], v[74:75], v[238:239]
  v_pk_fma_f32 v[74:75], v[122:123], v[136:137], v[74:75] op_sel_hi:[1,0,1]
  v_cvt_pk_bf16_f32 v249, v74, v75
  v_pk_mul_f32 v[76:77], v[76:77], v[240:241]
  v_pk_fma_f32 v[76:77], v[124:125], v[136:137], v[76:77] op_sel_hi:[1,0,1]
  v_cvt_pk_bf16_f32 v250, v76, v77
  v_pk_mul_f32 v[78:79], v[78:79], v[242:243]
  v_pk_fma_f32 v[78:79], v[126:127], v[136:137], v[78:79] op_sel_hi:[1,0,1]
  v_cvt_pk_bf16_f32 v251, v78, v79
  s_waitcnt lgkmcnt(0)
  v_mfma_f32_32x32x16_bf16 v[32:47], v[212:215], v[244:247], 0
  v_mfma_f32_32x32x16_bf16 v[180:195], v[212:215], v[252:255], 0
  v_mfma_f32_32x32x16_bf16 v[48:63], v[220:223], v[244:247], 0
  v_mfma_f32_32x32x16_bf16 v[196:211], v[220:223], v[252:255], 0
  v_mfma_f32_32x32x16_bf16 v[32:47], v[216:219], v[248:251], v[32:47]
  v_mfma_f32_32x32x16_bf16 v[180:195], v[216:219], v[252:255], v[180:195]
  v_mfma_f32_32x32x16_bf16 v[48:63], v[224:227], v[248:251], v[48:63]
  v_mfma_f32_32x32x16_bf16 v[196:211], v[224:227], v[252:255], v[196:211]
  s_nop 7
  ds_read_b128 v[228:231], v162 offset:128
  ds_read_b128 v[112:115], v162 offset:1152
  ds_read_b128 v[232:235], v162 offset:160
  ds_read_b128 v[116:119], v162 offset:1184
  ds_read_b128 v[236:239], v162 offset:192
  ds_read_b128 v[120:123], v162 offset:1216
  ds_read_b128 v[240:243], v162 offset:224
  ds_read_b128 v[124:127], v162 offset:1248
  ds_read_b64_tr_b16 v[212:213], v161 offset:4608
  ds_read_b64_tr_b16 v[214:215], v161 offset:5760
  ds_read_b64_tr_b16 v[216:217], v161 offset:6912
  ds_read_b64_tr_b16 v[218:219], v161 offset:8064
  ds_read_b64_tr_b16 v[220:221], v161 offset:4672
  ds_read_b64_tr_b16 v[222:223], v161 offset:5824
  ds_read_b64_tr_b16 v[224:225], v161 offset:6976
  ds_read_b64_tr_b16 v[226:227], v161 offset:8128
  s_waitcnt lgkmcnt(8)
  v_pk_mul_f32 v[80:81], v[80:81], v[228:229]
  v_pk_fma_f32 v[80:81], v[112:113], v[136:137], v[80:81] op_sel_hi:[1,0,1]
  v_cvt_pk_bf16_f32 v244, v80, v81
  v_pk_mul_f32 v[82:83], v[82:83], v[230:231]
  v_pk_fma_f32 v[82:83], v[114:115], v[136:137], v[82:83] op_sel_hi:[1,0,1]
  v_cvt_pk_bf16_f32 v245, v82, v83
  v_pk_mul_f32 v[84:85], v[84:85], v[232:233]
  v_pk_fma_f32 v[84:85], v[116:117], v[136:137], v[84:85] op_sel_hi:[1,0,1]
  v_cvt_pk_bf16_f32 v246, v84, v85
  v_pk_mul_f32 v[86:87], v[86:87], v[234:235]
  v_pk_fma_f32 v[86:87], v[118:119], v[136:137], v[86:87] op_sel_hi:[1,0,1]
  v_cvt_pk_bf16_f32 v247, v86, v87
  v_pk_mul_f32 v[88:89], v[88:89], v[236:237]
  v_pk_fma_f32 v[88:89], v[120:121], v[136:137], v[88:89] op_sel_hi:[1,0,1]
  v_cvt_pk_bf16_f32 v248, v88, v89
  v_pk_mul_f32 v[90:91], v[90:91], v[238:239]
  v_pk_fma_f32 v[90:91], v[122:123], v[136:137], v[90:91] op_sel_hi:[1,0,1]
  v_cvt_pk_bf16_f32 v249, v90, v91
  v_pk_mul_f32 v[92:93], v[92:93], v[240:241]
  v_pk_fma_f32 v[92:93], v[124:125], v[136:137], v[92:93] op_sel_hi:[1,0,1]
  v_cvt_pk_bf16_f32 v250, v92, v93
  v_pk_mul_f32 v[94:95], v[94:95], v[242:243]
  v_pk_fma_f32 v[94:95], v[126:127], v[136:137], v[94:95] op_sel_hi:[1,0,1]
  v_cvt_pk_bf16_f32 v251, v94, v95
  s_waitcnt lgkmcnt(0)
  v_mfma_f32_32x32x16_bf16 v[32:47], v[212:215], v[244:247], v[32:47]
  v_mfma_f32_32x32x16_bf16 v[180:195], v[212:215], v[252:255], v[180:195]
  v_mfma_f32_32x32x16_bf16 v[48:63], v[220:223], v[244:247], v[48:63]
  v_mfma_f32_32x32x16_bf16 v[196:211], v[220:223], v[252:255], v[196:211]
  v_mfma_f32_32x32x16_bf16 v[32:47], v[216:219], v[248:251], v[32:47]
  v_mfma_f32_32x32x16_bf16 v[180:195], v[216:219], v[252:255], v[180:195]
  v_mfma_f32_32x32x16_bf16 v[48:63], v[224:227], v[248:251], v[48:63]
  v_mfma_f32_32x32x16_bf16 v[196:211], v[224:227], v[252:255], v[196:211]
  s_nop 7
  s_nop 7
  s_nop 4
  s_mul_i32 s52, s40, 8704
  s_add_u32 s52, s52, 36864
  v_lshlrev_b32 v145, 4, v144
  v_add_u32 v146, s52, v145
  ds_write_b128 v146, v[32:35] offset:0
  ds_write_b128 v146, v[36:39] offset:1024
  ds_write_b128 v146, v[40:43] offset:2048
  ds_write_b128 v146, v[44:47] offset:3072
  ds_write_b128 v146, v[48:51] offset:4096
  ds_write_b128 v146, v[52:55] offset:5120
  ds_write_b128 v146, v[56:59] offset:6144
  ds_write_b128 v146, v[60:63] offset:7168
  v_lshlrev_b32 v147, 4, v152
  v_add_u32 v147, s52, v147
  v_and_b32 v148, 31, v144
  v_cmp_eq_u32 vcc, 0, v148
  s_and_saveexec_b64 s[58:59], vcc
  ds_write_b128 v147, v[180:183] offset:8192
  ds_write_b128 v147, v[184:187] offset:8224
  ds_write_b128 v147, v[188:191] offset:8256
  ds_write_b128 v147, v[192:195] offset:8288
  ds_write_b128 v147, v[196:199] offset:8320
  ds_write_b128 v147, v[200:203] offset:8352
  ds_write_b128 v147, v[204:207] offset:8384
  ds_write_b128 v147, v[208:211] offset:8416
  s_mov_b64 exec, s[58:59]
  s_waitcnt lgkmcnt(0)
  s_barrier
  s_lshl_b32 s52, s40, 11
  s_add_u32 s52, s52, 36864
  v_add_u32 v146, s52, v145
  ds_read_b128 v[32:35], v146 offset:0
  ds_read_b128 v[36:39], v146 offset:1024
  ds_read_b128 v[40:43], v146 offset:8704
  ds_read_b128 v[44:47], v146 offset:9728
  ds_read_b128 v[48:51], v146 offset:17408
  ds_read_b128 v[52:55], v146 offset:18432
  ds_read_b128 v[56:59], v146 offset:26112
  ds_read_b128 v[60:63], v146 offset:27136
  v_add_u32 v147, 45056, v145
  v_and_b32 v148, 0xff, v145
  v_add_u32 v147, 45056, v148
  ds_read_b128 v[180:183], v147 offset:0
  ds_read_b128 v[184:187], v147 offset:8704
  ds_read_b128 v[188:191], v147 offset:17408
  ds_read_b128 v[192:195], v147 offset:26112
  s_waitcnt lgkmcnt(0)
  v_pk_add_f32 v[32:33], v[32:33], v[40:41]
  v_pk_add_f32 v[34:35], v[34:35], v[42:43]
  v_pk_add_f32 v[36:37], v[36:37], v[44:45]
  v_pk_add_f32 v[38:39], v[38:39], v[46:47]
  v_pk_add_f32 v[180:181], v[180:181], v[184:185]
  v_pk_add_f32 v[182:183], v[182:183], v[186:187]
  v_pk_add_f32 v[32:33], v[32:33], v[48:49]
  v_pk_add_f32 v[34:35], v[34:35], v[50:51]
  v_pk_add_f32 v[36:37], v[36:37], v[52:53]
  v_pk_add_f32 v[38:39], v[38:39], v[54:55]
  v_pk_add_f32 v[180:181], v[180:181], v[188:189]
  v_pk_add_f32 v[182:183], v[182:183], v[190:191]
  v_pk_add_f32 v[32:33], v[32:33], v[56:57]
  v_pk_add_f32 v[34:35], v[34:35], v[58:59]
  v_pk_add_f32 v[36:37], v[36:37], v[60:61]
  v_pk_add_f32 v[38:39], v[38:39], v[62:63]
  v_pk_add_f32 v[180:181], v[180:181], v[192:193]
  v_pk_add_f32 v[182:183], v[182:183], v[194:195]
  s_mul_i32 s52, s41, 8704
  s_lshl_b32 s53, s40, 11
  s_add_u32 s53, s53, s52
  buffer_store_dwordx4 v[32:35], v145, s[28:31], s53 offen offset:0 sc1
  buffer_store_dwordx4 v[36:39], v145, s[28:31], s53 offen offset:1024 sc1
  s_cmp_lg_u32 s40, 0
  s_cbranch_scc1 Lz_33
  v_add_u32 v147, 8192, v145
  v_cmp_gt_u32 vcc, 16, v144
  v_mov_b32 v148, 0x7fffffff
  s_nop 0
  v_cndmask_b32 v147, v148, v147, vcc
  buffer_store_dwordx4 v[180:183], v147, s[28:31], s52 offen sc1
Lz_33:
  s_waitcnt vmcnt(0)
  s_barrier
  s_cmp_lg_u32 s40, 0
  s_cbranch_scc1 Lflag_34
  s_lshl_b32 s52, s42, 9
  s_lshl_b32 s53, s41, 6
  s_add_u32 s52, s52, s53
  s_add_u32 s52, s52, 33554432
  v_lshlrev_b32 v145, 3, v144
  v_add_u32 v145, s52, v145
  s_mov_b64 s[58:59], exec
  s_mov_b64 exec, 0xff
  global_store_dwordx2 v145, v[154:155], s[4:5] sc1
  s_mov_b64 exec, s[58:59]
Lflag_34:
  v_pk_mul_f32 v[0:1], v[0:1], v[128:129] op_sel_hi:[1,0]
  v_pk_fma_f32 v[0:1], v[96:97], v[132:133], v[0:1] op_sel_hi:[1,0,1]
  v_cvt_pk_bf16_f32 v172, v0, v1
  v_pk_mul_f32 v[2:3], v[2:3], v[128:129] op_sel_hi:[1,0]
  v_pk_fma_f32 v[2:3], v[98:99], v[132:133], v[2:3] op_sel_hi:[1,0,1]
  v_cvt_pk_bf16_f32 v173, v2, v3
  v_pk_mul_f32 v[4:5], v[4:5], v[128:129] op_sel_hi:[1,0]
  v_pk_fma_f32 v[4:5], v[100:101], v[132:133], v[4:5] op_sel_hi:[1,0,1]
  v_cvt_pk_bf16_f32 v174, v4, v5
  v_pk_mul_f32 v[6:7], v[6:7], v[128:129] op_sel_hi:[1,0]
  v_pk_fma_f32 v[6:7], v[102:103], v[132:133], v[6:7] op_sel_hi:[1,0,1]
  v_cvt_pk_bf16_f32 v175, v6, v7
  v_pk_mul_f32 v[8:9], v[8:9], v[128:129] op_sel_hi:[1,0]
  v_pk_fma_f32 v[8:9], v[104:105], v[132:133], v[8:9] op_sel_hi:[1,0,1]
  v_cvt_pk_bf16_f32 v176, v8, v9
  v_pk_mul_f32 v[10:11], v[10:11], v[128:129] op_sel_hi:[1,0]
  v_pk_fma_f32 v[10:11], v[106:107], v[132:133], v[10:11] op_sel_hi:[1,0,1]
  v_cvt_pk_bf16_f32 v177, v10, v11
  v_pk_mul_f32 v[12:13], v[12:13], v[128:129] op_sel_hi:[1,0]
  v_pk_fma_f32 v[12:13], v[108:109], v[132:133], v[12:13] op_sel_hi:[1,0,1]
  v_cvt_pk_bf16_f32 v178, v12, v13
  v_pk_mul_f32 v[14:15], v[14:15], v[128:129] op_sel_hi:[1,0]
  v_pk_fma_f32 v[14:15], v[110:111], v[132:133], v[14:15] op_sel_hi:[1,0,1]
  v_cvt_pk_bf16_f32 v179, v14, v15
  s_nop 1
  v_mfma_f32_32x32x16_bf16 v[180:195], v[164:167], v[172:175], 0
  v_mfma_f32_32x32x16_bf16 v[180:195], v[168:171], v[176:179], v[180:195]
  s_nop 7
  s_nop 4
  v_max3_f32 v228, v180, v181, v182
  v_min3_f32 v229, v180, v181, v182
  v_max3_f32 v228, v228, v183, v184
  v_min3_f32 v229, v229, v183, v184
  v_max3_f32 v228, v228, v185, v186
  v_min3_f32 v229, v229, v185, v186
  v_max3_f32 v228, v228, v187, v188
  v_min3_f32 v229, v229, v187, v188
  v_max3_f32 v228, v228, v189, v190
  v_min3_f32 v229, v229, v189, v190
  v_max3_f32 v228, v228, v191, v192
  v_min3_f32 v229, v229, v191, v192
  v_max3_f32 v228, v228, v193, v194
  v_min3_f32 v229, v229, v193, v194
  v_max_f32 v228, v228, v195
  v_min_f32 v229, v229, v195
  v_mov_b32 v230, v228
  v_mov_b32 v231, v229
  s_nop 1
  v_permlane32_swap_b32 v230, v228
  v_permlane32_swap_b32 v231, v229
  v_max_f32 v228, v228, v230
  v_min_f32 v229, v229, v231
  v_mul_f32 v228, s56, v228
  v_mul_f32 v229, s56, v229
  v_mov_b32 v232, v229
  v_pk_fma_f32 v[196:197], v[180:181], s[56:57], v[228:229] op_sel_hi:[1,0,0] neg_lo:[0,0,1] neg_hi:[0,0,1]
  v_pk_fma_f32 v[198:199], v[182:183], s[56:57], v[228:229] op_sel_hi:[1,0,0] neg_lo:[0,0,1] neg_hi:[0,0,1]
  v_pk_fma_f32 v[200:201], v[184:185], s[56:57], v[228:229] op_sel_hi:[1,0,0] neg_lo:[0,0,1] neg_hi:[0,0,1]
  v_pk_fma_f32 v[202:203], v[186:187], s[56:57], v[228:229] op_sel_hi:[1,0,0] neg_lo:[0,0,1] neg_hi:[0,0,1]
  v_pk_fma_f32 v[204:205], v[188:189], s[56:57], v[228:229] op_sel_hi:[1,0,0] neg_lo:[0,0,1] neg_hi:[0,0,1]
  v_pk_fma_f32 v[206:207], v[190:191], s[56:57], v[228:229] op_sel_hi:[1,0,0] neg_lo:[0,0,1] neg_hi:[0,0,1]
  v_pk_fma_f32 v[208:209], v[192:193], s[56:57], v[228:229] op_sel_hi:[1,0,0] neg_lo:[0,0,1] neg_hi:[0,0,1]
  v_pk_fma_f32 v[210:211], v[194:195], s[56:57], v[228:229] op_sel_hi:[1,0,0] neg_lo:[0,0,1] neg_hi:[0,0,1]
  v_exp_f32 v196, v196
  v_exp_f32 v197, v197
  v_exp_f32 v198, v198
  v_exp_f32 v199, v199
  v_exp_f32 v200, v200
  v_exp_f32 v201, v201
  v_exp_f32 v202, v202
  v_exp_f32 v203, v203
  v_exp_f32 v204, v204
  v_exp_f32 v205, v205
  v_exp_f32 v206, v206
  v_exp_f32 v207, v207
  v_exp_f32 v208, v208
  v_exp_f32 v209, v209
  v_exp_f32 v210, v210
  v_exp_f32 v211, v211
  s_nop 0
  v_pk_add_f32 v[230:231], v[196:197], v[198:199]
  v_pk_add_f32 v[234:235], v[200:201], v[202:203]
  v_pk_add_f32 v[230:231], v[230:231], v[204:205]
  v_pk_add_f32 v[234:235], v[234:235], v[206:207]
  v_pk_add_f32 v[230:231], v[230:231], v[208:209]
  v_pk_add_f32 v[234:235], v[234:235], v[210:211]
  v_pk_add_f32 v[230:231], v[230:231], v[234:235]
  v_add_f32 v230, v230, v231
  v_mov_b32 v231, v230
  s_nop 1
  v_permlane32_swap_b32 v231, v230
  v_add_f32 v230, v230, v231
  v_rcp_f32 v234, v230
  s_nop 0
  v_pk_mul_f32 v[196:197], v[196:197], v[234:235] op_sel_hi:[1,0]
  v_cvt_pk_bf16_f32 v212, v196, v197
  v_pk_mul_f32 v[198:199], v[198:199], v[234:235] op_sel_hi:[1,0]
  v_cvt_pk_bf16_f32 v213, v198, v199
  v_pk_mul_f32 v[200:201], v[200:201], v[234:235] op_sel_hi:[1,0]
  v_cvt_pk_bf16_f32 v214, v200, v201
  v_pk_mul_f32 v[202:203], v[202:203], v[234:235] op_sel_hi:[1,0]
  v_cvt_pk_bf16_f32 v215, v202, v203
  v_pk_mul_f32 v[204:205], v[204:205], v[234:235] op_sel_hi:[1,0]
  v_cvt_pk_bf16_f32 v216, v204, v205
  v_pk_mul_f32 v[206:207], v[206:207], v[234:235] op_sel_hi:[1,0]
  v_cvt_pk_bf16_f32 v217, v206, v207
  v_pk_mul_f32 v[208:209], v[208:209], v[234:235] op_sel_hi:[1,0]
  v_cvt_pk_bf16_f32 v218, v208, v209
  v_pk_mul_f32 v[210:211], v[210:211], v[234:235] op_sel_hi:[1,0]
  v_cvt_pk_bf16_f32 v219, v210, v211
  v_pk_fma_f32 v[196:197], v[180:181], s[56:57], v[232:233] op_sel_hi:[1,0,0] neg_lo:[1,0,0] neg_hi:[1,0,0]
  v_pk_fma_f32 v[198:199], v[182:183], s[56:57], v[232:233] op_sel_hi:[1,0,0] neg_lo:[1,0,0] neg_hi:[1,0,0]
  v_pk_fma_f32 v[200:201], v[184:185], s[56:57], v[232:233] op_sel_hi:[1,0,0] neg_lo:[1,0,0] neg_hi:[1,0,0]
  v_pk_fma_f32 v[202:203], v[186:187], s[56:57], v[232:233] op_sel_hi:[1,0,0] neg_lo:[1,0,0] neg_hi:[1,0,0]
  v_pk_fma_f32 v[204:205], v[188:189], s[56:57], v[232:233] op_sel_hi:[1,0,0] neg_lo:[1,0,0] neg_hi:[1,0,0]
  v_pk_fma_f32 v[206:207], v[190:191], s[56:57], v[232:233] op_sel_hi:[1,0,0] neg_lo:[1,0,0] neg_hi:[1,0,0]
  v_pk_fma_f32 v[208:209], v[192:193], s[56:57], v[232:233] op_sel_hi:[1,0,0] neg_lo:[1,0,0] neg_hi:[1,0,0]
  v_pk_fma_f32 v[210:211], v[194:195], s[56:57], v[232:233] op_sel_hi:[1,0,0] neg_lo:[1,0,0] neg_hi:[1,0,0]
  v_exp_f32 v196, v196
  v_exp_f32 v197, v197
  v_exp_f32 v198, v198
  v_exp_f32 v199, v199
  v_exp_f32 v200, v200
  v_exp_f32 v201, v201
  v_exp_f32 v202, v202
  v_exp_f32 v203, v203
  v_exp_f32 v204, v204
  v_exp_f32 v205, v205
  v_exp_f32 v206, v206
  v_exp_f32 v207, v207
  v_exp_f32 v208, v208
  v_exp_f32 v209, v209
  v_exp_f32 v210, v210
  v_exp_f32 v211, v211
  s_nop 0
  v_pk_add_f32 v[230:231], v[196:197], v[198:199]
  v_pk_add_f32 v[234:235], v[200:201], v[202:203]
  v_pk_add_f32 v[230:231], v[230:231], v[204:205]
  v_pk_add_f32 v[234:235], v[234:235], v[206:207]
  v_pk_add_f32 v[230:231], v[230:231], v[208:209]
  v_pk_add_f32 v[234:235], v[234:235], v[210:211]
  v_pk_add_f32 v[230:231], v[230:231], v[234:235]
  v_add_f32 v230, v230, v231
  v_mov_b32 v231, v230
  s_nop 1
  v_permlane32_swap_b32 v231, v230
  v_add_f32 v230, v230, v231
  v_rcp_f32 v234, v230
  s_nop 0
  v_pk_mul_f32 v[196:197], v[196:197], v[234:235] op_sel_hi:[1,0]
  v_cvt_pk_bf16_f32 v220, v196, v197
  v_pk_mul_f32 v[198:199], v[198:199], v[234:235] op_sel_hi:[1,0]
  v_cvt_pk_bf16_f32 v221, v198, v199
  v_pk_mul_f32 v[200:201], v[200:201], v[234:235] op_sel_hi:[1,0]
  v_cvt_pk_bf16_f32 v222, v200, v201
  v_pk_mul_f32 v[202:203], v[202:203], v[234:235] op_sel_hi:[1,0]
  v_cvt_pk_bf16_f32 v223, v202, v203
  v_pk_mul_f32 v[204:205], v[204:205], v[234:235] op_sel_hi:[1,0]
  v_cvt_pk_bf16_f32 v224, v204, v205
  v_pk_mul_f32 v[206:207], v[206:207], v[234:235] op_sel_hi:[1,0]
  v_cvt_pk_bf16_f32 v225, v206, v207
  v_pk_mul_f32 v[208:209], v[208:209], v[234:235] op_sel_hi:[1,0]
  v_cvt_pk_bf16_f32 v226, v208, v209
  v_pk_mul_f32 v[210:211], v[210:211], v[234:235] op_sel_hi:[1,0]
  v_cvt_pk_bf16_f32 v227, v210, v211
  v_mov_b32 v32, v212
  v_mov_b32 v40, v220
  v_mov_b32 v33, v213
  v_mov_b32 v41, v221
  v_mov_b32 v34, v214
  v_mov_b32 v42, v222
  v_mov_b32 v35, v215
  v_mov_b32 v43, v223
  v_mov_b32 v36, v216
  v_mov_b32 v44, v224
  v_mov_b32 v37, v217
  v_mov_b32 v45, v225
  v_mov_b32 v38, v218
  v_mov_b32 v46, v226
  v_mov_b32 v39, v219
  v_mov_b32 v47, v227
  v_pk_mul_f32 v[16:17], v[16:17], v[130:131] op_sel_hi:[1,0]
  v_pk_fma_f32 v[16:17], v[96:97], v[134:135], v[16:17] op_sel_hi:[1,0,1]
  v_cvt_pk_bf16_f32 v172, v16, v17
  v_pk_mul_f32 v[18:19], v[18:19], v[130:131] op_sel_hi:[1,0]
  v_pk_fma_f32 v[18:19], v[98:99], v[134:135], v[18:19] op_sel_hi:[1,0,1]
  v_cvt_pk_bf16_f32 v173, v18, v19
  v_pk_mul_f32 v[20:21], v[20:21], v[130:131] op_sel_hi:[1,0]
  v_pk_fma_f32 v[20:21], v[100:101], v[134:135], v[20:21] op_sel_hi:[1,0,1]
  v_cvt_pk_bf16_f32 v174, v20, v21
  v_pk_mul_f32 v[22:23], v[22:23], v[130:131] op_sel_hi:[1,0]
  v_pk_fma_f32 v[22:23], v[102:103], v[134:135], v[22:23] op_sel_hi:[1,0,1]
  v_cvt_pk_bf16_f32 v175, v22, v23
  v_pk_mul_f32 v[24:25], v[24:25], v[130:131] op_sel_hi:[1,0]
  v_pk_fma_f32 v[24:25], v[104:105], v[134:135], v[24:25] op_sel_hi:[1,0,1]
  v_cvt_pk_bf16_f32 v176, v24, v25
  v_pk_mul_f32 v[26:27], v[26:27], v[130:131] op_sel_hi:[1,0]
  v_pk_fma_f32 v[26:27], v[106:107], v[134:135], v[26:27] op_sel_hi:[1,0,1]
  v_cvt_pk_bf16_f32 v177, v26, v27
  v_pk_mul_f32 v[28:29], v[28:29], v[130:131] op_sel_hi:[1,0]
  v_pk_fma_f32 v[28:29], v[108:109], v[134:135], v[28:29] op_sel_hi:[1,0,1]
  v_cvt_pk_bf16_f32 v178, v28, v29
  v_pk_mul_f32 v[30:31], v[30:31], v[130:131] op_sel_hi:[1,0]
  v_pk_fma_f32 v[30:31], v[110:111], v[134:135], v[30:31] op_sel_hi:[1,0,1]
  v_cvt_pk_bf16_f32 v179, v30, v31
  s_nop 1
  v_mfma_f32_32x32x16_bf16 v[180:195], v[164:167], v[172:175], 0
  v_mfma_f32_32x32x16_bf16 v[180:195], v[168:171], v[176:179], v[180:195]
  s_nop 7
  s_nop 4
  v_max3_f32 v228, v180, v181, v182
  v_min3_f32 v229, v180, v181, v182
  v_max3_f32 v228, v228, v183, v184
  v_min3_f32 v229, v229, v183, v184
  v_max3_f32 v228, v228, v185, v186
  v_min3_f32 v229, v229, v185, v186
  v_max3_f32 v228, v228, v187, v188
  v_min3_f32 v229, v229, v187, v188
  v_max3_f32 v228, v228, v189, v190
  v_min3_f32 v229, v229, v189, v190
  v_max3_f32 v228, v228, v191, v192
  v_min3_f32 v229, v229, v191, v192
  v_max3_f32 v228, v228, v193, v194
  v_min3_f32 v229, v229, v193, v194
  v_max_f32 v228, v228, v195
  v_min_f32 v229, v229, v195
  v_mov_b32 v230, v228
  v_mov_b32 v231, v229
  s_nop 1
  v_permlane32_swap_b32 v230, v228
  v_permlane32_swap_b32 v231, v229
  v_max_f32 v228, v228, v230
  v_min_f32 v229, v229, v231
  v_mul_f32 v228, s56, v228
  v_mul_f32 v229, s56, v229
  v_mov_b32 v232, v229
  v_pk_fma_f32 v[196:197], v[180:181], s[56:57], v[228:229] op_sel_hi:[1,0,0] neg_lo:[0,0,1] neg_hi:[0,0,1]
  v_pk_fma_f32 v[198:199], v[182:183], s[56:57], v[228:229] op_sel_hi:[1,0,0] neg_lo:[0,0,1] neg_hi:[0,0,1]
  v_pk_fma_f32 v[200:201], v[184:185], s[56:57], v[228:229] op_sel_hi:[1,0,0] neg_lo:[0,0,1] neg_hi:[0,0,1]
  v_pk_fma_f32 v[202:203], v[186:187], s[56:57], v[228:229] op_sel_hi:[1,0,0] neg_lo:[0,0,1] neg_hi:[0,0,1]
  v_pk_fma_f32 v[204:205], v[188:189], s[56:57], v[228:229] op_sel_hi:[1,0,0] neg_lo:[0,0,1] neg_hi:[0,0,1]
  v_pk_fma_f32 v[206:207], v[190:191], s[56:57], v[228:229] op_sel_hi:[1,0,0] neg_lo:[0,0,1] neg_hi:[0,0,1]
  v_pk_fma_f32 v[208:209], v[192:193], s[56:57], v[228:229] op_sel_hi:[1,0,0] neg_lo:[0,0,1] neg_hi:[0,0,1]
  v_pk_fma_f32 v[210:211], v[194:195], s[56:57], v[228:229] op_sel_hi:[1,0,0] neg_lo:[0,0,1] neg_hi:[0,0,1]
  v_exp_f32 v196, v196
  v_exp_f32 v197, v197
  v_exp_f32 v198, v198
  v_exp_f32 v199, v199
  v_exp_f32 v200, v200
  v_exp_f32 v201, v201
  v_exp_f32 v202, v202
  v_exp_f32 v203, v203
  v_exp_f32 v204, v204
  v_exp_f32 v205, v205
  v_exp_f32 v206, v206
  v_exp_f32 v207, v207
  v_exp_f32 v208, v208
  v_exp_f32 v209, v209
  v_exp_f32 v210, v210
  v_exp_f32 v211, v211
  s_nop 0
  v_pk_add_f32 v[230:231], v[196:197], v[198:199]
  v_pk_add_f32 v[234:235], v[200:201], v[202:203]
  v_pk_add_f32 v[230:231], v[230:231], v[204:205]
  v_pk_add_f32 v[234:235], v[234:235], v[206:207]
  v_pk_add_f32 v[230:231], v[230:231], v[208:209]
  v_pk_add_f32 v[234:235], v[234:235], v[210:211]
  v_pk_add_f32 v[230:231], v[230:231], v[234:235]
  v_add_f32 v230, v230, v231
  v_mov_b32 v231, v230
  s_nop 1
  v_permlane32_swap_b32 v231, v230
  v_add_f32 v230, v230, v231
  v_rcp_f32 v234, v230
  s_nop 0
  v_pk_mul_f32 v[196:197], v[196:197], v[234:235] op_sel_hi:[1,0]
  v_cvt_pk_bf16_f32 v212, v196, v197
  v_pk_mul_f32 v[198:199], v[198:199], v[234:235] op_sel_hi:[1,0]
  v_cvt_pk_bf16_f32 v213, v198, v199
  v_pk_mul_f32 v[200:201], v[200:201], v[234:235] op_sel_hi:[1,0]
  v_cvt_pk_bf16_f32 v214, v200, v201
  v_pk_mul_f32 v[202:203], v[202:203], v[234:235] op_sel_hi:[1,0]
  v_cvt_pk_bf16_f32 v215, v202, v203
  v_pk_mul_f32 v[204:205], v[204:205], v[234:235] op_sel_hi:[1,0]
  v_cvt_pk_bf16_f32 v216, v204, v205
  v_pk_mul_f32 v[206:207], v[206:207], v[234:235] op_sel_hi:[1,0]
  v_cvt_pk_bf16_f32 v217, v206, v207
  v_pk_mul_f32 v[208:209], v[208:209], v[234:235] op_sel_hi:[1,0]
  v_cvt_pk_bf16_f32 v218, v208, v209
  v_pk_mul_f32 v[210:211], v[210:211], v[234:235] op_sel_hi:[1,0]
  v_cvt_pk_bf16_f32 v219, v210, v211
  v_pk_fma_f32 v[196:197], v[180:181], s[56:57], v[232:233] op_sel_hi:[1,0,0] neg_lo:[1,0,0] neg_hi:[1,0,0]
  v_pk_fma_f32 v[198:199], v[182:183], s[56:57], v[232:233] op_sel_hi:[1,0,0] neg_lo:[1,0,0] neg_hi:[1,0,0]
  v_pk_fma_f32 v[200:201], v[184:185], s[56:57], v[232:233] op_sel_hi:[1,0,0] neg_lo:[1,0,0] neg_hi:[1,0,0]
  v_pk_fma_f32 v[202:203], v[186:187], s[56:57], v[232:233] op_sel_hi:[1,0,0] neg_lo:[1,0,0] neg_hi:[1,0,0]
  v_pk_fma_f32 v[204:205], v[188:189], s[56:57], v[232:233] op_sel_hi:[1,0,0] neg_lo:[1,0,0] neg_hi:[1,0,0]
  v_pk_fma_f32 v[206:207], v[190:191], s[56:57], v[232:233] op_sel_hi:[1,0,0] neg_lo:[1,0,0] neg_hi:[1,0,0]
  v_pk_fma_f32 v[208:209], v[192:193], s[56:57], v[232:233] op_sel_hi:[1,0,0] neg_lo:[1,0,0] neg_hi:[1,0,0]
  v_pk_fma_f32 v[210:211], v[194:195], s[56:57], v[232:233] op_sel_hi:[1,0,0] neg_lo:[1,0,0] neg_hi:[1,0,0]
  v_exp_f32 v196, v196
  v_exp_f32 v197, v197
  v_exp_f32 v198, v198
  v_exp_f32 v199, v199
  v_exp_f32 v200, v200
  v_exp_f32 v201, v201
  v_exp_f32 v202, v202
  v_exp_f32 v203, v203
  v_exp_f32 v204, v204
  v_exp_f32 v205, v205
  v_exp_f32 v206, v206
  v_exp_f32 v207, v207
  v_exp_f32 v208, v208
  v_exp_f32 v209, v209
  v_exp_f32 v210, v210
  v_exp_f32 v211, v211
  s_nop 0
  v_pk_add_f32 v[230:231], v[196:197], v[198:199]
  v_pk_add_f32 v[234:235], v[200:201], v[202:203]
  v_pk_add_f32 v[230:231], v[230:231], v[204:205]
  v_pk_add_f32 v[234:235], v[234:235], v[206:207]
  v_pk_add_f32 v[230:231], v[230:231], v[208:209]
  v_pk_add_f32 v[234:235], v[234:235], v[210:211]
  v_pk_add_f32 v[230:231], v[230:231], v[234:235]
  v_add_f32 v230, v230, v231
  v_mov_b32 v231, v230
  s_nop 1
  v_permlane32_swap_b32 v231, v230
  v_add_f32 v230, v230, v231
  v_rcp_f32 v234, v230
  s_nop 0
  v_pk_mul_f32 v[196:197], v[196:197], v[234:235] op_sel_hi:[1,0]
  v_cvt_pk_bf16_f32 v220, v196, v197
  v_pk_mul_f32 v[198:199], v[198:199], v[234:235] op_sel_hi:[1,0]
  v_cvt_pk_bf16_f32 v221, v198, v199
  v_pk_mul_f32 v[200:201], v[200:201], v[234:235] op_sel_hi:[1,0]
  v_cvt_pk_bf16_f32 v222, v200, v201
  v_pk_mul_f32 v[202:203], v[202:203], v[234:235] op_sel_hi:[1,0]
  v_cvt_pk_bf16_f32 v223, v202, v203
  v_pk_mul_f32 v[204:205], v[204:205], v[234:235] op_sel_hi:[1,0]
  v_cvt_pk_bf16_f32 v224, v204, v205
  v_pk_mul_f32 v[206:207], v[206:207], v[234:235] op_sel_hi:[1,0]
  v_cvt_pk_bf16_f32 v225, v206, v207
  v_pk_mul_f32 v[208:209], v[208:209], v[234:235] op_sel_hi:[1,0]
  v_cvt_pk_bf16_f32 v226, v208, v209
  v_pk_mul_f32 v[210:211], v[210:211], v[234:235] op_sel_hi:[1,0]
  v_cvt_pk_bf16_f32 v227, v210, v211
  v_mov_b32 v48, v212
  v_mov_b32 v56, v220
  v_mov_b32 v49, v213
  v_mov_b32 v57, v221
  v_mov_b32 v50, v214
  v_mov_b32 v58, v222
  v_mov_b32 v51, v215
  v_mov_b32 v59, v223
  v_mov_b32 v52, v216
  v_mov_b32 v60, v224
  v_mov_b32 v53, v217
  v_mov_b32 v61, v225
  v_mov_b32 v54, v218
  v_mov_b32 v62, v226
  v_mov_b32 v55, v219
  v_mov_b32 v63, v227
  s_barrier
  v_lshlrev_b32 v145, 4, v144
  v_add_u32 v145, 71680, v145
  v_lshlrev_b32 v146, 4, v152
  v_add_u32 v146, 75776, v146
  ds_read_b128 v[64:67], v145 offset:0
  ds_read_b128 v[80:83], v146 offset:0
  ds_read_b128 v[68:71], v145 offset:1024
  ds_read_b128 v[84:87], v146 offset:32
  ds_read_b128 v[72:75], v145 offset:2048
  ds_read_b128 v[88:91], v146 offset:64
  ds_read_b128 v[76:79], v145 offset:3072
  ds_read_b128 v[92:95], v146 offset:96
  s_waitcnt lgkmcnt(0)
  v_mfma_f32_32x32x16_bf16 v[96:111], v[64:67], v[32:35], 0
  v_mfma_f32_32x32x16_bf16 v[180:195], v[80:83], v[32:35], 0
  v_mfma_f32_32x32x16_bf16 v[96:111], v[68:71], v[36:39], v[96:111]
  v_mfma_f32_32x32x16_bf16 v[180:195], v[84:87], v[36:39], v[180:195]
  v_mfma_f32_32x32x16_bf16 v[96:111], v[72:75], v[40:43], v[96:111]
  v_mfma_f32_32x32x16_bf16 v[180:195], v[88:91], v[40:43], v[180:195]
  v_mfma_f32_32x32x16_bf16 v[96:111], v[76:79], v[44:47], v[96:111]
  v_mfma_f32_32x32x16_bf16 v[180:195], v[92:95], v[44:47], v[180:195]
  v_mfma_f32_32x32x16_bf16 v[112:127], v[64:67], v[48:51], 0
  v_mfma_f32_32x32x16_bf16 v[196:211], v[80:83], v[48:51], 0
  v_mfma_f32_32x32x16_bf16 v[112:127], v[68:71], v[52:55], v[112:127]
  v_mfma_f32_32x32x16_bf16 v[196:211], v[84:87], v[52:55], v[196:211]
  v_mfma_f32_32x32x16_bf16 v[112:127], v[72:75], v[56:59], v[112:127]
  v_mfma_f32_32x32x16_bf16 v[196:211], v[88:91], v[56:59], v[196:211]
  v_mfma_f32_32x32x16_bf16 v[112:127], v[76:79], v[60:63], v[112:127]
  v_mfma_f32_32x32x16_bf16 v[196:211], v[92:95], v[60:63], v[196:211]
  s_nop 7
  s_nop 4
  v_and_b32 v145, 31, v144
  v_mul_u32_u24 v145, 80, v145
  v_lshl_add_u32 v145, v152, 3, v145
  s_mul_i32 s52, s40, 5120
  s_add_u32 s52, s52, 0
  v_add_u32 v145, s52, v145
  v_lshrrev_b32 v147, 2, v144
  v_and_b32 v148, 3, v144
  v_lshlrev_b32 v148, 4, v148
  v_mul_u32_u24 v149, 80, v147
  v_add3_u32 v149, v149, v148, s52
  s_lshl_b32 s53, s40, 6
  v_add_u32 v147, s53, v147
  v_and_b32 v150, 1, v147
  v_lshl_add_u32 v148, v150, 6, v148
  v_lshrrev_b32 v147, 1, v147
  v_mul_u32_u24 v147, 4224, v147
  v_add_u32 v147, v147, v148
  v_add_f32 v146, 0x358637bd, v180
  v_rcp_f32 v146, v146
  s_nop 0
  v_mul_f32 v96, v96, v146
  v_mul_f32 v97, v97, v146
  v_mul_f32 v98, v98, v146
  v_mul_f32 v99, v99, v146
  v_mul_f32 v100, v100, v146
  v_mul_f32 v101, v101, v146
  v_mul_f32 v102, v102, v146
  v_mul_f32 v103, v103, v146
  v_mul_f32 v104, v104, v146
  v_mul_f32 v105, v105, v146
  v_mul_f32 v106, v106, v146
  v_mul_f32 v107, v107, v146
  v_mul_f32 v108, v108, v146
  v_mul_f32 v109, v109, v146
  v_mul_f32 v110, v110, v146
  v_mul_f32 v111, v111, v146
  v_cvt_pk_bf16_f32 v212, v96, v97
  v_cvt_pk_bf16_f32 v213, v98, v99
  v_cvt_pk_bf16_f32 v214, v100, v101
  v_cvt_pk_bf16_f32 v215, v102, v103
  v_cvt_pk_bf16_f32 v216, v104, v105
  v_cvt_pk_bf16_f32 v217, v106, v107
  v_cvt_pk_bf16_f32 v218, v108, v109
  v_cvt_pk_bf16_f32 v219, v110, v111
  ds_write_b64 v145, v[212:213] offset:0
  ds_write_b64 v145, v[214:215] offset:16
  ds_write_b64 v145, v[216:217] offset:32
  ds_write_b64 v145, v[218:219] offset:48
  v_add_f32 v146, 0x358637bd, v196
  v_rcp_f32 v146, v146
  s_nop 0
  v_mul_f32 v112, v112, v146
  v_mul_f32 v113, v113, v146
  v_mul_f32 v114, v114, v146
  v_mul_f32 v115, v115, v146
  v_mul_f32 v116, v116, v146
  v_mul_f32 v117, v117, v146
  v_mul_f32 v118, v118, v146
  v_mul_f32 v119, v119, v146
  v_mul_f32 v120, v120, v146
  v_mul_f32 v121, v121, v146
  v_mul_f32 v122, v122, v146
  v_mul_f32 v123, v123, v146
  v_mul_f32 v124, v124, v146
  v_mul_f32 v125, v125, v146
  v_mul_f32 v126, v126, v146
  v_mul_f32 v127, v127, v146
  v_cvt_pk_bf16_f32 v220, v112, v113
  v_cvt_pk_bf16_f32 v221, v114, v115
  v_cvt_pk_bf16_f32 v222, v116, v117
  v_cvt_pk_bf16_f32 v223, v118, v119
  v_cvt_pk_bf16_f32 v224, v120, v121
  v_cvt_pk_bf16_f32 v225, v122, v123
  v_cvt_pk_bf16_f32 v226, v124, v125
  v_cvt_pk_bf16_f32 v227, v126, v127
  ds_write_b64 v145, v[220:221] offset:2560
  ds_write_b64 v145, v[222:223] offset:2576
  ds_write_b64 v145, v[224:225] offset:2592
  ds_write_b64 v145, v[226:227] offset:2608
  ds_read_b128 v[64:67], v149 offset:0
  ds_read_b128 v[68:71], v149 offset:1280
  ds_read_b128 v[72:75], v149 offset:2560
  ds_read_b128 v[76:79], v149 offset:3840
  s_waitcnt lgkmcnt(3)
  s_mov_b32 s53, 0
  buffer_store_dwordx4 v[64:67], v147, s[24:27], s53 offen sc1
  s_waitcnt lgkmcnt(2)
  s_mov_b32 s53, 33792
  buffer_store_dwordx4 v[68:71], v147, s[24:27], s53 offen sc1
  s_waitcnt lgkmcnt(1)
  s_mov_b32 s53, 67584
  buffer_store_dwordx4 v[72:75], v147, s[24:27], s53 offen sc1
  s_waitcnt lgkmcnt(0)
  s_mov_b32 s53, 101376
  buffer_store_dwordx4 v[76:79], v147, s[24:27], s53 offen sc1
  s_waitcnt vmcnt(0)
Ljoin_2:
  v_mov_b32 v145, 142336
  ds_read_b64 v[154:155], v145
  s_waitcnt lgkmcnt(0)
  v_readfirstlane_b32 s72, v154
  v_readfirstlane_b32 s73, v155
  s_barrier
  s_cmp_lg_u32 s40, 0
  s_cbranch_scc1 Lfo_35
  s_lshl_b32 s52, s41, 5
  s_add_u32 s52, s52, s42
  s_lshl_b32 s52, s52, 6
  s_add_u32 s52, s52, 33751040
  v_lshlrev_b32 v145, 3, v144
  v_add_u32 v145, s52, v145
  s_mov_b64 s[58:59], exec
  s_mov_b64 exec, 0xff
  global_store_dwordx2 v145, v[154:155], s[4:5] sc1
  s_mov_b64 exec, s[58:59]
Lfo_35:
  s_load_dwordx2 s[8:9], s[0:1], 56
  s_load_dwordx2 s[64:65], s[0:1], 24
  s_load_dwordx2 s[66:67], s[0:1], 40
  s_load_dwordx2 s[68:69], s[0:1], 48
  s_load_dwordx2 s[70:71], s[0:1], 64
  s_waitcnt lgkmcnt(0)
  v_mbcnt_lo_u32_b32 v96, -1, 0
  v_mbcnt_hi_u32_b32 v96, -1, v96
  s_and_b32 s52, s2, 7
  s_lshr_b32 s53, s2, 3
  s_and_b32 s54, s52, 3
  s_lshr_b32 s55, s52, 2
  s_lshl_b32 s41, s54, 3
  s_and_b32 s54, s53, 7
  s_add_u32 s41, s41, s54
  s_lshl_b32 s42, s55, 2
  s_lshr_b32 s54, s53, 3
  s_add_u32 s42, s42, s54
  s_mul_i32 s52, s41, 135168
  s_add_u32 s52, s52, 0
  s_add_u32 s12, s4, s52
  s_addc_u32 s13, s5, 0
  s_mov_b32 s16, s12
  s_and_b32 s17, s13, 0xffff
  s_mov_b32 s18, 0x21000
  s_mov_b32 s19, 0x00020000
  s_mul_i32 s52, s42, 256
  s_add_u32 s12, s64, s52
  s_addc_u32 s13, s65, 0
  s_sub_u32 s53, 2097152, s52
  s_mov_b32 s20, s12
  s_and_b32 s21, s13, 0xffff
  s_mov_b32 s22, s53
  s_mov_b32 s23, 0x00020000
  s_cmp_lt_u32 s40, 4
  s_cbranch_scc1 Lconsumer_36
  s_sub_u32 s43, s40, 4
  s_mov_b32 s46, 0
  s_mov_b32 s47, 0
  v_lshrrev_b32 v103, 3, v96
  v_and_b32 v104, 7, v96
  s_mul_i32 s52, s43, 16
  v_add_u32 v105, s52, v103
  v_bfe_u32 v106, v105, 1, 3
  v_xor_b32 v106, v106, v104
  v_lshrrev_b32 v107, 2, v106
  v_lshlrev_b32 v107, 7, v107
  v_and_b32 v106, 3, v106
  v_lshl_add_u32 v106, v106, 4, v107
  v_and_b32 v107, 1, v105
  v_lshl_add_u32 v106, v107, 6, v106
  v_lshrrev_b32 v105, 1, v105
  s_mov_b32 s53, 4224
  v_mul_lo_u32 v105, v105, s53
  v_add_u32 v32, v105, v106
  v_add_u32 v105, s52, v103
  v_add_u32 v105, 8, v105
  v_bfe_u32 v106, v105, 1, 3
  v_xor_b32 v106, v106, v104
  v_lshrrev_b32 v107, 2, v106
  v_lshlrev_b32 v107, 7, v107
  v_and_b32 v106, 3, v106
  v_lshl_add_u32 v106, v106, 4, v107
  v_and_b32 v107, 1, v105
  v_lshl_add_u32 v106, v107, 6, v106
  v_lshrrev_b32 v105, 1, v105
  s_mov_b32 s53, 4224
  v_mul_lo_u32 v105, v105, s53
  v_add_u32 v33, v105, v106
  s_mul_i32 s52, s43, 256
  v_add_u32 v103, s52, v96
  v_mul_u32_u24 v104, 16, v103
  v_lshrrev_b32 v104, 8, v104
  v_mul_u32_u24 v105, 16, v104
  v_sub_u32 v105, v103, v105
  v_bfe_u32 v106, v104, 0, 1
  v_lshlrev_b32 v106, 1, v106
  v_xor_b32 v105, v105, v106
  v_bfe_u32 v106, v104, 1, 1
  v_lshlrev_b32 v106, 2, v106
  v_xor_b32 v105, v105, v106
  v_bfe_u32 v106, v104, 3, 1
  v_lshlrev_b32 v106, 3, v106
  v_xor_b32 v105, v105, v106
  v_lshlrev_b32 v105, 4, v105
  s_mov_b32 s53, 2048
  v_mul_lo_u32 v104, v104, s53
  v_add_u32 v34, v104, v105
  v_add_u32 v103, s52, v96
  v_add_u32 v103, 64, v103
  v_mul_u32_u24 v104, 16, v103
  v_lshrrev_b32 v104, 8, v104
  v_mul_u32_u24 v105, 16, v104
  v_sub_u32 v105, v103, v105
  v_bfe_u32 v106, v104, 0, 1
  v_lshlrev_b32 v106, 1, v106
  v_xor_b32 v105, v105, v106
  v_bfe_u32 v106, v104, 1, 1
  v_lshlrev_b32 v106, 2, v106
  v_xor_b32 v105, v105, v106
  v_bfe_u32 v106, v104, 3, 1
  v_lshlrev_b32 v106, 3, v106
  v_xor_b32 v105, v105, v106
  v_lshlrev_b32 v105, 4, v105
  s_mov_b32 s53, 2048
  v_mul_lo_u32 v104, v104, s53
  v_add_u32 v35, v104, v105
  v_add_u32 v103, s52, v96
  v_add_u32 v103, 128, v103
  v_mul_u32_u24 v104, 16, v103
  v_lshrrev_b32 v104, 8, v104
  v_mul_u32_u24 v105, 16, v104
  v_sub_u32 v105, v103, v105
  v_bfe_u32 v106, v104, 0, 1
  v_lshlrev_b32 v106, 1, v106
  v_xor_b32 v105, v105, v106
  v_bfe_u32 v106, v104, 1, 1
  v_lshlrev_b32 v106, 2, v106
  v_xor_b32 v105, v105, v106
  v_bfe_u32 v106, v104, 3, 1
  v_lshlrev_b32 v106, 3, v106
  v_xor_b32 v105, v105, v106
  v_lshlrev_b32 v105, 4, v105
  s_mov_b32 s53, 2048
  v_mul_lo_u32 v104, v104, s53
  v_add_u32 v36, v104, v105
  v_add_u32 v103, s52, v96
  v_add_u32 v103, 192, v103
  v_mul_u32_u24 v104, 16, v103
  v_lshrrev_b32 v104, 8, v104
  v_mul_u32_u24 v105, 16, v104
  v_sub_u32 v105, v103, v105
  v_bfe_u32 v106, v104, 0, 1
  v_lshlrev_b32 v106, 1, v106
  v_xor_b32 v105, v105, v106
  v_bfe_u32 v106, v104, 1, 1
  v_lshlrev_b32 v106, 2, v106
  v_xor_b32 v105, v105, v106
  v_bfe_u32 v106, v104, 3, 1
  v_lshlrev_b32 v106, 3, v106
  v_xor_b32 v105, v105, v106
  v_lshlrev_b32 v105, 4, v105
  s_mov_b32 s53, 2048
  v_mul_lo_u32 v104, v104, s53
  v_add_u32 v37, v104, v105
  s_mul_i32 s48, s43, 2048
  s_mul_i32 s49, s43, 4096
  s_add_u32 s49, s49, 49152
  s_mov_b32 s45, 0
  s_mov_b32 s51, 0
  s_add_u32 m0, s51, s49
  s_nop 0
  buffer_load_dwordx4 v34, s[20:23], s47 offen lds
  s_add_u32 m0, m0, 0x400
  s_nop 0
  buffer_load_dwordx4 v35, s[20:23], s47 offen lds
  s_add_u32 m0, m0, 0x400
  s_nop 0
  buffer_load_dwordx4 v36, s[20:23], s47 offen lds
  s_add_u32 m0, m0, 0x400
  s_nop 0
  buffer_load_dwordx4 v37, s[20:23], s47 offen lds
  s_add_u32 s51, s51, 16384
  s_cmp_eq_u32 s51, 98304
  s_cselect_b32 s51, 0, s51
  s_add_u32 s47, s47, 131072
  s_add_u32 m0, s51, s49
  s_nop 0
  buffer_load_dwordx4 v34, s[20:23], s47 offen lds
  s_add_u32 m0, m0, 0x400
  s_nop 0
  buffer_load_dwordx4 v35, s[20:23], s47 offen lds
  s_add_u32 m0, m0, 0x400
  s_nop 0
  buffer_load_dwordx4 v36, s[20:23], s47 offen lds
  s_add_u32 m0, m0, 0x400
  s_nop 0
  buffer_load_dwordx4 v37, s[20:23], s47 offen lds
  s_add_u32 s51, s51, 16384
  s_cmp_eq_u32 s51, 98304
  s_cselect_b32 s51, 0, s51
  s_add_u32 s47, s47, 131072
  s_add_u32 m0, s51, s49
  s_nop 0
  buffer_load_dwordx4 v34, s[20:23], s47 offen lds
  s_add_u32 m0, m0, 0x400
  s_nop 0
  buffer_load_dwordx4 v35, s[20:23], s47 offen lds
  s_add_u32 m0, m0, 0x400
  s_nop 0
  buffer_load_dwordx4 v36, s[20:23], s47 offen lds
  s_add_u32 m0, m0, 0x400
  s_nop 0
  buffer_load_dwordx4 v37, s[20:23], s47 offen lds
  s_add_u32 s51, s51, 16384
  s_cmp_eq_u32 s51, 98304
  s_cselect_b32 s51, 0, s51
  s_add_u32 s47, s47, 131072
  s_add_u32 m0, s51, s49
  s_nop 0
  buffer_load_dwordx4 v34, s[20:23], s47 offen lds
  s_add_u32 m0, m0, 0x400
  s_nop 0
  buffer_load_dwordx4 v35, s[20:23], s47 offen lds
  s_add_u32 m0, m0, 0x400
  s_nop 0
  buffer_load_dwordx4 v36, s[20:23], s47 offen lds
  s_add_u32 m0, m0, 0x400
  s_nop 0
  buffer_load_dwordx4 v37, s[20:23], s47 offen lds
  s_add_u32 s51, s51, 16384
  s_cmp_eq_u32 s51, 98304
  s_cselect_b32 s51, 0, s51
  s_add_u32 s47, s47, 131072
  s_add_u32 m0, s51, s49
  s_nop 0
  buffer_load_dwordx4 v34, s[20:23], s47 offen lds
  s_add_u32 m0, m0, 0x400
  s_nop 0
  buffer_load_dwordx4 v35, s[20:23], s47 offen lds
  s_add_u32 m0, m0, 0x400
  s_nop 0
  buffer_load_dwordx4 v36, s[20:23], s47 offen lds
  s_add_u32 m0, m0, 0x400
  s_nop 0
  buffer_load_dwordx4 v37, s[20:23], s47 offen lds
  s_add_u32 s51, s51, 16384
  s_cmp_eq_u32 s51, 98304
  s_cselect_b32 s51, 0, s51
  s_add_u32 s47, s47, 131072
  s_cmp_lt_u32 s40, 6
  s_cbranch_scc1 Lnocs_39
  s_waitcnt vmcnt(24)
  s_cmp_ge_u32 s76, 16
  s_cbranch_scc1 Lskipcs_40
  v_lshlrev_b32 v103, 16, v164
  v_and_b32 v104, 0xffff0000, v164
  v_mov_b32 v124, v103
  v_mov_b32 v125, v104
  v_lshlrev_b32 v103, 16, v165
  v_and_b32 v104, 0xffff0000, v165
  v_mov_b32 v126, v103
  v_mov_b32 v127, v104
  v_lshlrev_b32 v103, 16, v166
  v_and_b32 v104, 0xffff0000, v166
  v_mov_b32 v128, v103
  v_mov_b32 v129, v104
  v_lshlrev_b32 v103, 16, v167
  v_and_b32 v104, 0xffff0000, v167
  v_mov_b32 v130, v103
  v_mov_b32 v131, v104
  v_lshlrev_b32 v103, 16, v168
  v_and_b32 v104, 0xffff0000, v168
  v_add_f32 v124, v124, v103
  v_add_f32 v125, v125, v104
  v_lshlrev_b32 v103, 16, v169
  v_and_b32 v104, 0xffff0000, v169
  v_add_f32 v126, v126, v103
  v_add_f32 v127, v127, v104
  v_lshlrev_b32 v103, 16, v170
  v_and_b32 v104, 0xffff0000, v170
  v_add_f32 v128, v128, v103
  v_add_f32 v129, v129, v104
  v_lshlrev_b32 v103, 16, v171
  v_and_b32 v104, 0xffff0000, v171
  v_add_f32 v130, v130, v103
  v_add_f32 v131, v131, v104
  v_lshlrev_b32 v103, 16, v172
  v_and_b32 v104, 0xffff0000, v172
  v_add_f32 v124, v124, v103
  v_add_f32 v125, v125, v104
  v_lshlrev_b32 v103, 16, v173
  v_and_b32 v104, 0xffff0000, v173
  v_add_f32 v126, v126, v103
  v_add_f32 v127, v127, v104
  v_lshlrev_b32 v103, 16, v174
  v_and_b32 v104, 0xffff0000, v174
  v_add_f32 v128, v128, v103
  v_add_f32 v129, v129, v104
  v_lshlrev_b32 v103, 16, v175
  v_and_b32 v104, 0xffff0000, v175
  v_add_f32 v130, v130, v103
  v_add_f32 v131, v131, v104
  v_lshlrev_b32 v103, 16, v176
  v_and_b32 v104, 0xffff0000, v176
  v_add_f32 v124, v124, v103
  v_add_f32 v125, v125, v104
  v_lshlrev_b32 v103, 16, v177
  v_and_b32 v104, 0xffff0000, v177
  v_add_f32 v126, v126, v103
  v_add_f32 v127, v127, v104
  v_lshlrev_b32 v103, 16, v178
  v_and_b32 v104, 0xffff0000, v178
  v_add_f32 v128, v128, v103
  v_add_f32 v129, v129, v104
  v_lshlrev_b32 v103, 16, v179
  v_and_b32 v104, 0xffff0000, v179
  v_add_f32 v130, v130, v103
  v_add_f32 v131, v131, v104
  v_lshlrev_b32 v103, 16, v180
  v_and_b32 v104, 0xffff0000, v180
  v_add_f32 v124, v124, v103
  v_add_f32 v125, v125, v104
  v_lshlrev_b32 v103, 16, v181
  v_and_b32 v104, 0xffff0000, v181
  v_add_f32 v126, v126, v103
  v_add_f32 v127, v127, v104
  v_lshlrev_b32 v103, 16, v182
  v_and_b32 v104, 0xffff0000, v182
  v_add_f32 v128, v128, v103
  v_add_f32 v129, v129, v104
  v_lshlrev_b32 v103, 16, v183
  v_and_b32 v104, 0xffff0000, v183
  v_add_f32 v130, v130, v103
  v_add_f32 v131, v131, v104
  v_lshlrev_b32 v103, 16, v184
  v_and_b32 v104, 0xffff0000, v184
  v_add_f32 v124, v124, v103
  v_add_f32 v125, v125, v104
  v_lshlrev_b32 v103, 16, v185
  v_and_b32 v104, 0xffff0000, v185
  v_add_f32 v126, v126, v103
  v_add_f32 v127, v127, v104
  v_lshlrev_b32 v103, 16, v186
  v_and_b32 v104, 0xffff0000, v186
  v_add_f32 v128, v128, v103
  v_add_f32 v129, v129, v104
  v_lshlrev_b32 v103, 16, v187
  v_and_b32 v104, 0xffff0000, v187
  v_add_f32 v130, v130, v103
  v_add_f32 v131, v131, v104
  v_lshlrev_b32 v103, 16, v188
  v_and_b32 v104, 0xffff0000, v188
  v_add_f32 v124, v124, v103
  v_add_f32 v125, v125, v104
  v_lshlrev_b32 v103, 16, v189
  v_and_b32 v104, 0xffff0000, v189
  v_add_f32 v126, v126, v103
  v_add_f32 v127, v127, v104
  v_lshlrev_b32 v103, 16, v190
  v_and_b32 v104, 0xffff0000, v190
  v_add_f32 v128, v128, v103
  v_add_f32 v129, v129, v104
  v_lshlrev_b32 v103, 16, v191
  v_and_b32 v104, 0xffff0000, v191
  v_add_f32 v130, v130, v103
  v_add_f32 v131, v131, v104
  v_lshlrev_b32 v103, 16, v192
  v_and_b32 v104, 0xffff0000, v192
  v_add_f32 v124, v124, v103
  v_add_f32 v125, v125, v104
  v_lshlrev_b32 v103, 16, v193
  v_and_b32 v104, 0xffff0000, v193
  v_add_f32 v126, v126, v103
  v_add_f32 v127, v127, v104
  v_lshlrev_b32 v103, 16, v194
  v_and_b32 v104, 0xffff0000, v194
  v_add_f32 v128, v128, v103
  v_add_f32 v129, v129, v104
  v_lshlrev_b32 v103, 16, v195
  v_and_b32 v104, 0xffff0000, v195
  v_add_f32 v130, v130, v103
  v_add_f32 v131, v131, v104
  s_nop 1
  v_add_f32_dpp v132, v124, v124 row_ror:8 row_mask:0xf bank_mask:0xf
  v_add_f32_dpp v133, v125, v125 row_ror:8 row_mask:0xf bank_mask:0xf
  v_add_f32_dpp v134, v126, v126 row_ror:8 row_mask:0xf bank_mask:0xf
  v_add_f32_dpp v135, v127, v127 row_ror:8 row_mask:0xf bank_mask:0xf
  v_add_f32_dpp v136, v128, v128 row_ror:8 row_mask:0xf bank_mask:0xf
  v_add_f32_dpp v137, v129, v129 row_ror:8 row_mask:0xf bank_mask:0xf
  v_add_f32_dpp v138, v130, v130 row_ror:8 row_mask:0xf bank_mask:0xf
  v_add_f32_dpp v139, v131, v131 row_ror:8 row_mask:0xf bank_mask:0xf
  v_mov_b32 v124, v132
  v_mov_b32 v125, v133
  v_mov_b32 v126, v134
  v_mov_b32 v127, v135
  v_mov_b32 v128, v136
  v_mov_b32 v129, v137
  v_mov_b32 v130, v138
  v_mov_b32 v131, v139
  s_nop 1
  v_permlane16_swap_b32 v132, v124
  v_permlane16_swap_b32 v133, v125
  v_permlane16_swap_b32 v134, v126
  v_permlane16_swap_b32 v135, v127
  v_permlane16_swap_b32 v136, v128
  v_permlane16_swap_b32 v137, v129
  v_permlane16_swap_b32 v138, v130
  v_permlane16_swap_b32 v139, v131
  v_add_f32 v124, v124, v132
  v_add_f32 v125, v125, v133
  v_add_f32 v126, v126, v134
  v_add_f32 v127, v127, v135
  v_add_f32 v128, v128, v136
  v_add_f32 v129, v129, v137
  v_add_f32 v130, v130, v138
  v_add_f32 v131, v131, v139
  v_mov_b32 v132, v124
  v_mov_b32 v133, v125
  v_mov_b32 v134, v126
  v_mov_b32 v135, v127
  v_mov_b32 v136, v128
  v_mov_b32 v137, v129
  v_mov_b32 v138, v130
  v_mov_b32 v139, v131
  s_nop 1
  v_permlane32_swap_b32 v132, v124
  v_permlane32_swap_b32 v133, v125
  v_permlane32_swap_b32 v134, v126
  v_permlane32_swap_b32 v135, v127
  v_permlane32_swap_b32 v136, v128
  v_permlane32_swap_b32 v137, v129
  v_permlane32_swap_b32 v138, v130
  v_permlane32_swap_b32 v139, v131
  v_add_f32 v124, v124, v132
  v_add_f32 v125, v125, v133
  v_add_f32 v126, v126, v134
  v_add_f32 v127, v127, v135
  v_add_f32 v128, v128, v136
  v_add_f32 v129, v129, v137
  v_add_f32 v130, v130, v138
  v_add_f32 v131, v131, v139
  v_mov_b32 v132, v124
  v_mov_b32 v133, v125
  v_mov_b32 v134, v126
  v_mov_b32 v135, v127
  v_mov_b32 v136, v128
  v_mov_b32 v137, v129
  v_mov_b32 v138, v130
  v_mov_b32 v139, v131
  s_mul_i32 s52, s76, 14336
  s_lshl_b32 s53, s77, 8
  s_add_u32 s52, s52, s53
  s_add_u32 s52, s52, 31457280
  v_and_b32 v103, 7, v96
  v_lshlrev_b32 v103, 5, v103
  v_bfe_u32 v104, v96, 3, 1
  v_lshl_add_u32 v103, v104, 4, v103
  v_add_u32 v103, s52, v103
  v_cmp_eq_u32 vcc, 1, v104
  s_nop 1
  v_cndmask_b32 v124, v124, v128, vcc
  v_cndmask_b32 v125, v125, v129, vcc
  v_cndmask_b32 v126, v126, v130, vcc
  v_cndmask_b32 v127, v127, v131, vcc
  s_mov_b64 s[58:59], exec
  s_mov_b64 exec, 0xffff
  global_store_dwordx4 v103, v[124:127], s[4:5] sc1
  s_mov_b64 exec, s[58:59]
Lskipcs_40:
  s_cmp_ge_u32 s78, 16
  s_cbranch_scc1 Lskipcs_41
  v_lshlrev_b32 v103, 16, v196
  v_and_b32 v104, 0xffff0000, v196
  v_mov_b32 v124, v103
  v_mov_b32 v125, v104
  v_lshlrev_b32 v103, 16, v197
  v_and_b32 v104, 0xffff0000, v197
  v_mov_b32 v126, v103
  v_mov_b32 v127, v104
  v_lshlrev_b32 v103, 16, v198
  v_and_b32 v104, 0xffff0000, v198
  v_mov_b32 v128, v103
  v_mov_b32 v129, v104
  v_lshlrev_b32 v103, 16, v199
  v_and_b32 v104, 0xffff0000, v199
  v_mov_b32 v130, v103
  v_mov_b32 v131, v104
  v_lshlrev_b32 v103, 16, v200
  v_and_b32 v104, 0xffff0000, v200
  v_add_f32 v124, v124, v103
  v_add_f32 v125, v125, v104
  v_lshlrev_b32 v103, 16, v201
  v_and_b32 v104, 0xffff0000, v201
  v_add_f32 v126, v126, v103
  v_add_f32 v127, v127, v104
  v_lshlrev_b32 v103, 16, v202
  v_and_b32 v104, 0xffff0000, v202
  v_add_f32 v128, v128, v103
  v_add_f32 v129, v129, v104
  v_lshlrev_b32 v103, 16, v203
  v_and_b32 v104, 0xffff0000, v203
  v_add_f32 v130, v130, v103
  v_add_f32 v131, v131, v104
  v_lshlrev_b32 v103, 16, v204
  v_and_b32 v104, 0xffff0000, v204
  v_add_f32 v124, v124, v103
  v_add_f32 v125, v125, v104
  v_lshlrev_b32 v103, 16, v205
  v_and_b32 v104, 0xffff0000, v205
  v_add_f32 v126, v126, v103
  v_add_f32 v127, v127, v104
  v_lshlrev_b32 v103, 16, v206
  v_and_b32 v104, 0xffff0000, v206
  v_add_f32 v128, v128, v103
  v_add_f32 v129, v129, v104
  v_lshlrev_b32 v103, 16, v207
  v_and_b32 v104, 0xffff0000, v207
  v_add_f32 v130, v130, v103
  v_add_f32 v131, v131, v104
  v_lshlrev_b32 v103, 16, v208
  v_and_b32 v104, 0xffff0000, v208
  v_add_f32 v124, v124, v103
  v_add_f32 v125, v125, v104
  v_lshlrev_b32 v103, 16, v209
  v_and_b32 v104, 0xffff0000, v209
  v_add_f32 v126, v126, v103
  v_add_f32 v127, v127, v104
  v_lshlrev_b32 v103, 16, v210
  v_and_b32 v104, 0xffff0000, v210
  v_add_f32 v128, v128, v103
  v_add_f32 v129, v129, v104
  v_lshlrev_b32 v103, 16, v211
  v_and_b32 v104, 0xffff0000, v211
  v_add_f32 v130, v130, v103
  v_add_f32 v131, v131, v104
  v_lshlrev_b32 v103, 16, v212
  v_and_b32 v104, 0xffff0000, v212
  v_add_f32 v124, v124, v103
  v_add_f32 v125, v125, v104
  v_lshlrev_b32 v103, 16, v213
  v_and_b32 v104, 0xffff0000, v213
  v_add_f32 v126, v126, v103
  v_add_f32 v127, v127, v104
  v_lshlrev_b32 v103, 16, v214
  v_and_b32 v104, 0xffff0000, v214
  v_add_f32 v128, v128, v103
  v_add_f32 v129, v129, v104
  v_lshlrev_b32 v103, 16, v215
  v_and_b32 v104, 0xffff0000, v215
  v_add_f32 v130, v130, v103
  v_add_f32 v131, v131, v104
  v_lshlrev_b32 v103, 16, v216
  v_and_b32 v104, 0xffff0000, v216
  v_add_f32 v124, v124, v103
  v_add_f32 v125, v125, v104
  v_lshlrev_b32 v103, 16, v217
  v_and_b32 v104, 0xffff0000, v217
  v_add_f32 v126, v126, v103
  v_add_f32 v127, v127, v104
  v_lshlrev_b32 v103, 16, v218
  v_and_b32 v104, 0xffff0000, v218
  v_add_f32 v128, v128, v103
  v_add_f32 v129, v129, v104
  v_lshlrev_b32 v103, 16, v219
  v_and_b32 v104, 0xffff0000, v219
  v_add_f32 v130, v130, v103
  v_add_f32 v131, v131, v104
  v_lshlrev_b32 v103, 16, v220
  v_and_b32 v104, 0xffff0000, v220
  v_add_f32 v124, v124, v103
  v_add_f32 v125, v125, v104
  v_lshlrev_b32 v103, 16, v221
  v_and_b32 v104, 0xffff0000, v221
  v_add_f32 v126, v126, v103
  v_add_f32 v127, v127, v104
  v_lshlrev_b32 v103, 16, v222
  v_and_b32 v104, 0xffff0000, v222
  v_add_f32 v128, v128, v103
  v_add_f32 v129, v129, v104
  v_lshlrev_b32 v103, 16, v223
  v_and_b32 v104, 0xffff0000, v223
  v_add_f32 v130, v130, v103
  v_add_f32 v131, v131, v104
  v_lshlrev_b32 v103, 16, v224
  v_and_b32 v104, 0xffff0000, v224
  v_add_f32 v124, v124, v103
  v_add_f32 v125, v125, v104
  v_lshlrev_b32 v103, 16, v225
  v_and_b32 v104, 0xffff0000, v225
  v_add_f32 v126, v126, v103
  v_add_f32 v127, v127, v104
  v_lshlrev_b32 v103, 16, v226
  v_and_b32 v104, 0xffff0000, v226
  v_add_f32 v128, v128, v103
  v_add_f32 v129, v129, v104
  v_lshlrev_b32 v103, 16, v227
  v_and_b32 v104, 0xffff0000, v227
  v_add_f32 v130, v130, v103
  v_add_f32 v131, v131, v104
  s_nop 1
  v_add_f32_dpp v132, v124, v124 row_ror:8 row_mask:0xf bank_mask:0xf
  v_add_f32_dpp v133, v125, v125 row_ror:8 row_mask:0xf bank_mask:0xf
  v_add_f32_dpp v134, v126, v126 row_ror:8 row_mask:0xf bank_mask:0xf
  v_add_f32_dpp v135, v127, v127 row_ror:8 row_mask:0xf bank_mask:0xf
  v_add_f32_dpp v136, v128, v128 row_ror:8 row_mask:0xf bank_mask:0xf
  v_add_f32_dpp v137, v129, v129 row_ror:8 row_mask:0xf bank_mask:0xf
  v_add_f32_dpp v138, v130, v130 row_ror:8 row_mask:0xf bank_mask:0xf
  v_add_f32_dpp v139, v131, v131 row_ror:8 row_mask:0xf bank_mask:0xf
  v_mov_b32 v124, v132
  v_mov_b32 v125, v133
  v_mov_b32 v126, v134
  v_mov_b32 v127, v135
  v_mov_b32 v128, v136
  v_mov_b32 v129, v137
  v_mov_b32 v130, v138
  v_mov_b32 v131, v139
  s_nop 1
  v_permlane16_swap_b32 v132, v124
  v_permlane16_swap_b32 v133, v125
  v_permlane16_swap_b32 v134, v126
  v_permlane16_swap_b32 v135, v127
  v_permlane16_swap_b32 v136, v128
  v_permlane16_swap_b32 v137, v129
  v_permlane16_swap_b32 v138, v130
  v_permlane16_swap_b32 v139, v131
  v_add_f32 v124, v124, v132
  v_add_f32 v125, v125, v133
  v_add_f32 v126, v126, v134
  v_add_f32 v127, v127, v135
  v_add_f32 v128, v128, v136
  v_add_f32 v129, v129, v137
  v_add_f32 v130, v130, v138
  v_add_f32 v131, v131, v139
  v_mov_b32 v132, v124
  v_mov_b32 v133, v125
  v_mov_b32 v134, v126
  v_mov_b32 v135, v127
  v_mov_b32 v136, v128
  v_mov_b32 v137, v129
  v_mov_b32 v138, v130
  v_mov_b32 v139, v131
  s_nop 1
  v_permlane32_swap_b32 v132, v124
  v_permlane32_swap_b32 v133, v125
  v_permlane32_swap_b32 v134, v126
  v_permlane32_swap_b32 v135, v127
  v_permlane32_swap_b32 v136, v128
  v_permlane32_swap_b32 v137, v129
  v_permlane32_swap_b32 v138, v130
  v_permlane32_swap_b32 v139, v131
  v_add_f32 v124, v124, v132
  v_add_f32 v125, v125, v133
  v_add_f32 v126, v126, v134
  v_add_f32 v127, v127, v135
  v_add_f32 v128, v128, v136
  v_add_f32 v129, v129, v137
  v_add_f32 v130, v130, v138
  v_add_f32 v131, v131, v139
  v_mov_b32 v132, v124
  v_mov_b32 v133, v125
  v_mov_b32 v134, v126
  v_mov_b32 v135, v127
  v_mov_b32 v136, v128
  v_mov_b32 v137, v129
  v_mov_b32 v138, v130
  v_mov_b32 v139, v131
  s_mul_i32 s52, s78, 14336
  s_lshl_b32 s53, s79, 8
  s_add_u32 s52, s52, s53
  s_add_u32 s52, s52, 31457280
  v_and_b32 v103, 7, v96
  v_lshlrev_b32 v103, 5, v103
  v_bfe_u32 v104, v96, 3, 1
  v_lshl_add_u32 v103, v104, 4, v103
  v_add_u32 v103, s52, v103
  v_cmp_eq_u32 vcc, 1, v104
  s_nop 1
  v_cndmask_b32 v124, v124, v128, vcc
  v_cndmask_b32 v125, v125, v129, vcc
  v_cndmask_b32 v126, v126, v130, vcc
  v_cndmask_b32 v127, v127, v131, vcc
  s_mov_b64 s[58:59], exec
  s_mov_b64 exec, 0xffff
  global_store_dwordx4 v103, v[124:127], s[4:5] sc1
  s_mov_b64 exec, s[58:59]
Lskipcs_41:
Lnocs_39:
  s_cmp_lg_u32 s40, 4
  s_cbranch_scc1 Lnopoll_38
  s_lshr_b32 s52, s41, 2
  s_lshl_b32 s52, s52, 11
  s_add_u32 s52, s52, 33751040
  v_and_b32 v103, 31, v96
  v_lshlrev_b32 v103, 6, v103
  v_add_u32 v103, s52, v103
  v_mov_b32 v56, s72
  v_mov_b32 v57, s73
  s_mov_b32 s57, 0
Lpoll_42:
  global_load_dwordx2 v[58:59], v103, s[4:5] sc1
  s_waitcnt vmcnt(0)
  v_cmp_eq_u64 vcc, v[56:57], v[58:59]
  s_nop 4
  s_cmp_eq_u64 vcc, exec
  s_cbranch_scc1 Lpolld_43
  s_add_u32 s57, s57, 1
  s_cmp_gt_u32 s57, 0x40000
  s_cbranch_scc1 Lpolld_43
  s_sleep 4
  s_branch Lpoll_42
Lpolld_43:
Lnopoll_38:
  s_barrier
  s_add_u32 m0, s45, s48
  s_nop 0
  buffer_load_dwordx4 v32, s[16:19], s46 offen sc1 lds
  s_add_u32 m0, m0, 0x400
  s_nop 0
  buffer_load_dwordx4 v33, s[16:19], s46 offen sc1 lds
  s_add_u32 s45, s45, 8192
  s_cmp_eq_u32 s45, 49152
  s_cselect_b32 s45, 0, s45
  s_add_u32 s46, s46, 256
  s_add_u32 m0, s45, s48
  s_nop 0
  buffer_load_dwordx4 v32, s[16:19], s46 offen sc1 lds
  s_add_u32 m0, m0, 0x400
  s_nop 0
  buffer_load_dwordx4 v33, s[16:19], s46 offen sc1 lds
  s_add_u32 s45, s45, 8192
  s_cmp_eq_u32 s45, 49152
  s_cselect_b32 s45, 0, s45
  s_add_u32 s46, s46, 256
  s_add_u32 m0, s45, s48
  s_nop 0
  buffer_load_dwordx4 v32, s[16:19], s46 offen sc1 lds
  s_add_u32 m0, m0, 0x400
  s_nop 0
  buffer_load_dwordx4 v33, s[16:19], s46 offen sc1 lds
  s_add_u32 s45, s45, 8192
  s_cmp_eq_u32 s45, 49152
  s_cselect_b32 s45, 0, s45
  s_add_u32 s46, s46, 256
  s_add_u32 m0, s45, s48
  s_nop 0
  buffer_load_dwordx4 v32, s[16:19], s46 offen sc1 lds
  s_add_u32 m0, m0, 0x400
  s_nop 0
  buffer_load_dwordx4 v33, s[16:19], s46 offen sc1 lds
  s_add_u32 s45, s45, 8192
  s_cmp_eq_u32 s45, 49152
  s_cselect_b32 s45, 0, s45
  s_add_u32 s46, s46, 256
  s_add_u32 m0, s45, s48
  s_nop 0
  buffer_load_dwordx4 v32, s[16:19], s46 offen sc1 lds
  s_add_u32 m0, m0, 0x400
  s_nop 0
  buffer_load_dwordx4 v33, s[16:19], s46 offen sc1 lds
  s_add_u32 s45, s45, 8192
  s_cmp_eq_u32 s45, 49152
  s_cselect_b32 s45, 0, s45
  s_add_u32 s46, s46, 256
  s_waitcnt vmcnt(8)
  s_barrier
  s_add_u32 m0, s51, s49
  s_nop 0
  buffer_load_dwordx4 v34, s[20:23], s47 offen lds
  s_add_u32 m0, m0, 0x400
  s_nop 0
  buffer_load_dwordx4 v35, s[20:23], s47 offen lds
  s_add_u32 m0, m0, 0x400
  s_nop 0
  buffer_load_dwordx4 v36, s[20:23], s47 offen lds
  s_add_u32 m0, m0, 0x400
  s_nop 0
  buffer_load_dwordx4 v37, s[20:23], s47 offen lds
  s_add_u32 s51, s51, 16384
  s_cmp_eq_u32 s51, 98304
  s_cselect_b32 s51, 0, s51
  s_add_u32 s47, s47, 131072
  s_add_u32 m0, s45, s48
  s_nop 0
  buffer_load_dwordx4 v32, s[16:19], s46 offen sc1 lds
  s_add_u32 m0, m0, 0x400
  s_nop 0
  buffer_load_dwordx4 v33, s[16:19], s46 offen sc1 lds
  s_add_u32 s45, s45, 8192
  s_cmp_eq_u32 s45, 49152
  s_cselect_b32 s45, 0, s45
  s_add_u32 s46, s46, 256
  s_waitcnt vmcnt(12)
  s_barrier
  s_add_u32 m0, s51, s49
  s_nop 0
  buffer_load_dwordx4 v34, s[20:23], s47 offen lds
  s_add_u32 m0, m0, 0x400
  s_nop 0
  buffer_load_dwordx4 v35, s[20:23], s47 offen lds
  s_add_u32 m0, m0, 0x400
  s_nop 0
  buffer_load_dwordx4 v36, s[20:23], s47 offen lds
  s_add_u32 m0, m0, 0x400
  s_nop 0
  buffer_load_dwordx4 v37, s[20:23], s47 offen lds
  s_add_u32 s51, s51, 16384
  s_cmp_eq_u32 s51, 98304
  s_cselect_b32 s51, 0, s51
  s_add_u32 s47, s47, 131072
  s_add_u32 m0, s45, s48
  s_nop 0
  buffer_load_dwordx4 v32, s[16:19], s46 offen sc1 lds
  s_add_u32 m0, m0, 0x400
  s_nop 0
  buffer_load_dwordx4 v33, s[16:19], s46 offen sc1 lds
  s_add_u32 s45, s45, 8192
  s_cmp_eq_u32 s45, 49152
  s_cselect_b32 s45, 0, s45
  s_add_u32 s46, s46, 256
  s_waitcnt vmcnt(16)
  s_barrier
  s_add_u32 m0, s51, s49
  s_nop 0
  buffer_load_dwordx4 v34, s[20:23], s47 offen lds
  s_add_u32 m0, m0, 0x400
  s_nop 0
  buffer_load_dwordx4 v35, s[20:23], s47 offen lds
  s_add_u32 m0, m0, 0x400
  s_nop 0
  buffer_load_dwordx4 v36, s[20:23], s47 offen lds
  s_add_u32 m0, m0, 0x400
  s_nop 0
  buffer_load_dwordx4 v37, s[20:23], s47 offen lds
  s_add_u32 s51, s51, 16384
  s_cmp_eq_u32 s51, 98304
  s_cselect_b32 s51, 0, s51
  s_add_u32 s47, s47, 131072
  s_add_u32 m0, s45, s48
  s_nop 0
  buffer_load_dwordx4 v32, s[16:19], s46 offen sc1 lds
  s_add_u32 m0, m0, 0x400
  s_nop 0
  buffer_load_dwordx4 v33, s[16:19], s46 offen sc1 lds
  s_add_u32 s45, s45, 8192
  s_cmp_eq_u32 s45, 49152
  s_cselect_b32 s45, 0, s45
  s_add_u32 s46, s46, 256
  s_waitcnt vmcnt(20)
  s_barrier
  s_add_u32 m0, s51, s49
  s_nop 0
  buffer_load_dwordx4 v34, s[20:23], s47 offen lds
  s_add_u32 m0, m0, 0x400
  s_nop 0
  buffer_load_dwordx4 v35, s[20:23], s47 offen lds
  s_add_u32 m0, m0, 0x400
  s_nop 0
  buffer_load_dwordx4 v36, s[20:23], s47 offen lds
  s_add_u32 m0, m0, 0x400
  s_nop 0
  buffer_load_dwordx4 v37, s[20:23], s47 offen lds
  s_add_u32 s51, s51, 16384
  s_cmp_eq_u32 s51, 98304
  s_cselect_b32 s51, 0, s51
  s_add_u32 s47, s47, 131072
  s_add_u32 m0, s45, s48
  s_nop 0
  buffer_load_dwordx4 v32, s[16:19], s46 offen sc1 lds
  s_add_u32 m0, m0, 0x400
  s_nop 0
  buffer_load_dwordx4 v33, s[16:19], s46 offen sc1 lds
  s_add_u32 s45, s45, 8192
  s_cmp_eq_u32 s45, 49152
  s_cselect_b32 s45, 0, s45
  s_add_u32 s46, s46, 256
  s_mov_b32 s50, 0
Lprod_44:
  s_waitcnt vmcnt(24)
  s_barrier
  s_add_u32 m0, s51, s49
  s_nop 0
  buffer_load_dwordx4 v34, s[20:23], s47 offen lds
  s_add_u32 m0, m0, 0x400
  s_nop 0
  buffer_load_dwordx4 v35, s[20:23], s47 offen lds
  s_add_u32 m0, m0, 0x400
  s_nop 0
  buffer_load_dwordx4 v36, s[20:23], s47 offen lds
  s_add_u32 m0, m0, 0x400
  s_nop 0
  buffer_load_dwordx4 v37, s[20:23], s47 offen lds
  s_add_u32 s51, s51, 16384
  s_cmp_eq_u32 s51, 98304
  s_cselect_b32 s51, 0, s51
  s_add_u32 s47, s47, 131072
  s_add_u32 m0, s45, s48
  s_nop 0
  buffer_load_dwordx4 v32, s[16:19], s46 offen sc1 lds
  s_add_u32 m0, m0, 0x400
  s_nop 0
  buffer_load_dwordx4 v33, s[16:19], s46 offen sc1 lds
  s_add_u32 s45, s45, 8192
  s_cmp_eq_u32 s45, 49152
  s_cselect_b32 s45, 0, s45
  s_add_u32 s46, s46, 256
  s_add_u32 s50, s50, 1
  s_cmp_lt_u32 s50, 7
  s_cbranch_scc1 Lprod_44
  s_waitcnt vmcnt(24)
  s_barrier
  s_waitcnt vmcnt(18)
  s_barrier
  s_waitcnt vmcnt(12)
  s_barrier
  s_waitcnt vmcnt(6)
  s_barrier
  s_waitcnt vmcnt(0)
  s_barrier
  s_cmp_lt_u32 s40, 6
  s_cbranch_scc1 Lnoat_45
  s_waitcnt vmcnt(0)
  s_lshl_b32 s52, s2, 1
  s_add_u32 s52, s52, s40
  s_sub_u32 s52, s52, 6
  s_lshl_b32 s52, s52, 7
  s_add_u32 s52, s52, 33816576
  v_lshlrev_b32 v103, 3, v96
  v_add_u32 v103, s52, v103
  v_mov_b32 v56, s72
  v_mov_b32 v57, s73
  s_mov_b64 s[58:59], exec
  s_mov_b64 exec, 0xffff
  global_store_dwordx2 v103, v[56:57], s[4:5] sc1
  s_mov_b64 exec, s[58:59]
Lnoat_45:
  s_mul_i32 s52, s41, 139264
  s_mul_i32 s53, s42, 256
  s_add_u32 s52, s52, s53
  s_add_u32 s54, s52, 5242880
  s_add_u32 s12, s4, s54
  s_addc_u32 s13, s5, 0
  s_sub_u32 s53, 4456448, s52
  s_mov_b32 s24, s12
  s_and_b32 s25, s13, 0xffff
  s_mov_b32 s26, s53
  s_mov_b32 s27, 0x00020000
  s_mul_i32 s52, s41, 131072
  s_mul_i32 s53, s42, 256
  s_add_u32 s52, s52, s53
  s_sub_u32 s53, 4194304, s52
  s_add_u32 s12, s10, s52
  s_addc_u32 s13, s11, 0
  s_mov_b32 s28, s12
  s_and_b32 s29, s13, 0xffff
  s_mov_b32 s30, s53
  s_mov_b32 s31, 0x00020000
  s_lshl_b32 s52, s41, 3
  s_add_u32 s52, s52, s42
  s_lshl_b32 s52, s52, 9
  s_add_u32 s52, s52, 30408704
  s_add_u32 s12, s4, s52
  s_addc_u32 s13, s5, 0
  s_mov_b32 s32, s12
  s_and_b32 s33, s13, 0xffff
  s_mov_b32 s34, 0x200
  s_mov_b32 s35, 0x00020000
  s_barrier
  s_branch Lfinal_37
Lconsumer_36:
  s_lshr_b32 s43, s40, 1
  s_and_b32 s44, s40, 1
  s_mul_i32 s52, s41, 139264
  s_mul_i32 s53, s42, 256
  s_add_u32 s52, s52, s53
  s_add_u32 s54, s52, 5242880
  s_add_u32 s12, s4, s54
  s_addc_u32 s13, s5, 0
  s_sub_u32 s53, 4456448, s52
  s_mov_b32 s24, s12
  s_and_b32 s25, s13, 0xffff
  s_mov_b32 s26, s53
  s_mov_b32 s27, 0x00020000
  s_mul_i32 s52, s41, 131072
  s_mul_i32 s53, s42, 256
  s_add_u32 s52, s52, s53
  s_sub_u32 s53, 4194304, s52
  s_add_u32 s12, s10, s52
  s_addc_u32 s13, s11, 0
  s_mov_b32 s28, s12
  s_and_b32 s29, s13, 0xffff
  s_mov_b32 s30, s53
  s_mov_b32 s31, 0x00020000
  s_lshl_b32 s52, s41, 3
  s_add_u32 s52, s52, s42
  s_lshl_b32 s52, s52, 9
  s_add_u32 s52, s52, 30408704
  s_add_u32 s12, s4, s52
  s_addc_u32 s13, s5, 0
  s_mov_b32 s32, s12
  s_and_b32 s33, s13, 0xffff
  s_mov_b32 s34, 0x200
  s_mov_b32 s35, 0x00020000
  s_lshl_b32 s52, s2, 2
  s_add_u32 s52, s52, s40
  s_mul_i32 s52, s52, 7168
  v_lshlrev_b32 v103, 4, v96
  v_add_u32 v103, s52, v103
  global_load_dwordx4 v[124:127], v103, s[68:69] offset:0
  global_load_dwordx4 v[124:127], v103, s[68:69] offset:1024
  global_load_dwordx4 v[124:127], v103, s[68:69] offset:2048
  global_load_dwordx4 v[124:127], v103, s[68:69] offset:3072
  v_add_u32 v103, 4096, v103
  global_load_dwordx4 v[124:127], v103, s[68:69] offset:0
  global_load_dwordx4 v[124:127], v103, s[68:69] offset:1024
  global_load_dwordx4 v[124:127], v103, s[68:69] offset:2048
  v_and_b32 v103, 15, v96
  v_lshrrev_b32 v104, 4, v96
  v_lshrrev_b32 v105, 1, v103
  s_mul_i32 s52, s43, 32
  v_add_u32 v106, s52, v103
  v_lshlrev_b32 v106, 7, v106
  v_xor_b32 v105, v105, v104
  v_lshl_add_u32 v97, v105, 4, v106
  v_xor_b32 v105, 4, v105
  v_lshl_add_u32 v98, v105, 4, v106
  v_lshrrev_b32 v105, 2, v103
  v_lshl_add_u32 v106, v104, 3, v105
  v_mov_b32 v107, 0
  v_bfe_u32 v108, v106, 0, 1
  v_lshlrev_b32 v108, 0, v108
  v_or_b32 v107, v107, v108
  v_bfe_u32 v108, v106, 1, 1
  v_lshlrev_b32 v108, 1, v108
  v_or_b32 v107, v107, v108
  v_bfe_u32 v108, v106, 3, 1
  v_lshlrev_b32 v108, 2, v108
  v_or_b32 v107, v107, v108
  v_mul_u32_u24 v106, 256, v106
  v_and_b32 v105, 3, v103
  v_lshl_add_u32 v106, v105, 3, v106
  v_add_u32 v106, 49152, v106
  s_mul_i32 s52, s44, 4
  s_add_u32 s53, s52, 0
  v_xor_b32 v105, s53, v107
  v_lshl_add_u32 v99, v105, 5, v106
  s_add_u32 s53, s52, 1
  v_xor_b32 v105, s53, v107
  v_lshl_add_u32 v100, v105, 5, v106
  v_subrev_u32 v100, 32, v100
  s_add_u32 s53, s52, 2
  v_xor_b32 v105, s53, v107
  v_lshl_add_u32 v101, v105, 5, v106
  v_subrev_u32 v101, 64, v101
  s_add_u32 s53, s52, 3
  v_xor_b32 v105, s53, v107
  v_lshl_add_u32 v102, v105, 5, v106
  v_subrev_u32 v102, 96, v102
  s_barrier
  v_mov_b32 v0, 0
  v_mov_b32 v1, 0
  v_mov_b32 v2, 0
  v_mov_b32 v3, 0
  v_mov_b32 v4, 0
  v_mov_b32 v5, 0
  v_mov_b32 v6, 0
  v_mov_b32 v7, 0
  v_mov_b32 v8, 0
  v_mov_b32 v9, 0
  v_mov_b32 v10, 0
  v_mov_b32 v11, 0
  v_mov_b32 v12, 0
  v_mov_b32 v13, 0
  v_mov_b32 v14, 0
  v_mov_b32 v15, 0
  v_mov_b32 v16, 0
  v_mov_b32 v17, 0
  v_mov_b32 v18, 0
  v_mov_b32 v19, 0
  v_mov_b32 v20, 0
  v_mov_b32 v21, 0
  v_mov_b32 v22, 0
  v_mov_b32 v23, 0
  v_mov_b32 v24, 0
  v_mov_b32 v25, 0
  v_mov_b32 v26, 0
  v_mov_b32 v27, 0
  v_mov_b32 v28, 0
  v_mov_b32 v29, 0
  v_mov_b32 v30, 0
  v_mov_b32 v31, 0
  s_mov_b32 s45, 0
  s_mov_b32 s51, 0
  s_barrier
  ds_read_b64_tr_b16 v[40:41], v99 offset:0
  ds_read_b64_tr_b16 v[42:43], v99 offset:1024
  ds_read_b128 v[32:35], v97 offset:0
  ds_read_b128 v[36:39], v97 offset:2048
  ds_read_b64_tr_b16 v[44:45], v100 offset:32
  ds_read_b64_tr_b16 v[46:47], v100 offset:1056
  ds_read_b64_tr_b16 v[48:49], v101 offset:64
  ds_read_b64_tr_b16 v[50:51], v101 offset:1088
  ds_read_b64_tr_b16 v[52:53], v102 offset:96
  ds_read_b64_tr_b16 v[54:55], v102 offset:1120
  s_mov_b32 s50, 0
Lcons_47:
  s_waitcnt lgkmcnt(0)
  v_mfma_f32_16x16x32_bf16 v[0:3], v[40:43], v[32:35], v[0:3]
  ds_read_b64_tr_b16 v[64:65], v99 offset:8192
  ds_read_b64_tr_b16 v[66:67], v99 offset:9216
  v_mfma_f32_16x16x32_bf16 v[4:7], v[40:43], v[36:39], v[4:7]
  ds_read_b128 v[56:59], v98 offset:0
  ds_read_b128 v[60:63], v98 offset:2048
  v_mfma_f32_16x16x32_bf16 v[8:11], v[44:47], v[32:35], v[8:11]
  ds_read_b64_tr_b16 v[68:69], v100 offset:8224
  ds_read_b64_tr_b16 v[70:71], v100 offset:9248
  v_mfma_f32_16x16x32_bf16 v[12:15], v[44:47], v[36:39], v[12:15]
  ds_read_b64_tr_b16 v[72:73], v101 offset:8256
  ds_read_b64_tr_b16 v[74:75], v101 offset:9280
  v_mfma_f32_16x16x32_bf16 v[16:19], v[48:51], v[32:35], v[16:19]
  ds_read_b64_tr_b16 v[76:77], v102 offset:8288
  ds_read_b64_tr_b16 v[78:79], v102 offset:9312
  v_mfma_f32_16x16x32_bf16 v[20:23], v[48:51], v[36:39], v[20:23]
  v_mfma_f32_16x16x32_bf16 v[24:27], v[52:55], v[32:35], v[24:27]
  v_mfma_f32_16x16x32_bf16 v[28:31], v[52:55], v[36:39], v[28:31]
  s_waitcnt lgkmcnt(0)
  s_barrier
  s_add_u32 s45, s45, 8192
  s_mov_b32 s46, 8192
  s_cmp_eq_u32 s45, 49152
  s_cselect_b32 s45, 0, s45
  s_cselect_b32 s46, -40960, s46
  s_add_u32 s51, s51, 16384
  s_mov_b32 s47, 16384
  s_cmp_eq_u32 s51, 98304
  s_cselect_b32 s51, 0, s51
  s_cselect_b32 s47, -81920, s47
  v_add_u32 v97, s46, v97
  v_add_u32 v98, s46, v98
  v_add_u32 v99, s47, v99
  v_add_u32 v100, s47, v100
  v_add_u32 v101, s47, v101
  v_add_u32 v102, s47, v102
  v_mfma_f32_16x16x32_bf16 v[0:3], v[64:67], v[56:59], v[0:3]
  ds_read_b64_tr_b16 v[40:41], v99 offset:0
  ds_read_b64_tr_b16 v[42:43], v99 offset:1024
  v_mfma_f32_16x16x32_bf16 v[4:7], v[64:67], v[60:63], v[4:7]
  ds_read_b128 v[32:35], v97 offset:0
  ds_read_b128 v[36:39], v97 offset:2048
  v_mfma_f32_16x16x32_bf16 v[8:11], v[68:71], v[56:59], v[8:11]
  ds_read_b64_tr_b16 v[44:45], v100 offset:32
  ds_read_b64_tr_b16 v[46:47], v100 offset:1056
  v_mfma_f32_16x16x32_bf16 v[12:15], v[68:71], v[60:63], v[12:15]
  ds_read_b64_tr_b16 v[48:49], v101 offset:64
  ds_read_b64_tr_b16 v[50:51], v101 offset:1088
  v_mfma_f32_16x16x32_bf16 v[16:19], v[72:75], v[56:59], v[16:19]
  ds_read_b64_tr_b16 v[52:53], v102 offset:96
  ds_read_b64_tr_b16 v[54:55], v102 offset:1120
  v_mfma_f32_16x16x32_bf16 v[20:23], v[72:75], v[60:63], v[20:23]
  v_mfma_f32_16x16x32_bf16 v[24:27], v[76:79], v[56:59], v[24:27]
  v_mfma_f32_16x16x32_bf16 v[28:31], v[76:79], v[60:63], v[28:31]
  s_add_u32 s50, s50, 1
  s_cmp_lt_u32 s50, 15
  s_cbranch_scc1 Lcons_47
  s_waitcnt lgkmcnt(0)
  v_mfma_f32_16x16x32_bf16 v[0:3], v[40:43], v[32:35], v[0:3]
  ds_read_b64_tr_b16 v[64:65], v99 offset:8192
  ds_read_b64_tr_b16 v[66:67], v99 offset:9216
  v_mfma_f32_16x16x32_bf16 v[4:7], v[40:43], v[36:39], v[4:7]
  ds_read_b128 v[56:59], v98 offset:0
  ds_read_b128 v[60:63], v98 offset:2048
  v_mfma_f32_16x16x32_bf16 v[8:11], v[44:47], v[32:35], v[8:11]
  ds_read_b64_tr_b16 v[68:69], v100 offset:8224
  ds_read_b64_tr_b16 v[70:71], v100 offset:9248
  v_mfma_f32_16x16x32_bf16 v[12:15], v[44:47], v[36:39], v[12:15]
  ds_read_b64_tr_b16 v[72:73], v101 offset:8256
  ds_read_b64_tr_b16 v[74:75], v101 offset:9280
  v_mfma_f32_16x16x32_bf16 v[16:19], v[48:51], v[32:35], v[16:19]
  ds_read_b64_tr_b16 v[76:77], v102 offset:8288
  ds_read_b64_tr_b16 v[78:79], v102 offset:9312
  v_mfma_f32_16x16x32_bf16 v[20:23], v[48:51], v[36:39], v[20:23]
  v_mfma_f32_16x16x32_bf16 v[24:27], v[52:55], v[32:35], v[24:27]
  v_mfma_f32_16x16x32_bf16 v[28:31], v[52:55], v[36:39], v[28:31]
  s_waitcnt lgkmcnt(0)
  v_mfma_f32_16x16x32_bf16 v[0:3], v[64:67], v[56:59], v[0:3]
  v_mfma_f32_16x16x32_bf16 v[4:7], v[64:67], v[60:63], v[4:7]
  v_mfma_f32_16x16x32_bf16 v[8:11], v[68:71], v[56:59], v[8:11]
  v_mfma_f32_16x16x32_bf16 v[12:15], v[68:71], v[60:63], v[12:15]
  v_mfma_f32_16x16x32_bf16 v[16:19], v[72:75], v[56:59], v[16:19]
  v_mfma_f32_16x16x32_bf16 v[20:23], v[72:75], v[60:63], v[20:23]
  v_mfma_f32_16x16x32_bf16 v[24:27], v[76:79], v[56:59], v[24:27]
  v_mfma_f32_16x16x32_bf16 v[28:31], v[76:79], v[60:63], v[28:31]
  s_barrier
  s_nop 3
  v_and_b32 v103, 15, v96
  s_mul_i32 s52, s43, 32
  v_add_u32 v103, s52, v103
  v_mul_u32_u24 v104, 272, v103
  v_lshrrev_b32 v105, 4, v96
  v_lshl_add_u32 v104, v105, 3, v104
  s_mul_i32 s52, s44, 128
  s_add_u32 s52, s52, 0
  v_add_u32 v104, s52, v104
  v_cvt_pk_bf16_f32 v0, v0, v1
  v_cvt_pk_bf16_f32 v1, v2, v3
  ds_write_b64 v104, v[0:1] offset:0
  v_cvt_pk_bf16_f32 v4, v4, v5
  v_cvt_pk_bf16_f32 v5, v6, v7
  ds_write_b64 v104, v[4:5] offset:4352
  v_cvt_pk_bf16_f32 v8, v8, v9
  v_cvt_pk_bf16_f32 v9, v10, v11
  ds_write_b64 v104, v[8:9] offset:32
  v_cvt_pk_bf16_f32 v12, v12, v13
  v_cvt_pk_bf16_f32 v13, v14, v15
  ds_write_b64 v104, v[12:13] offset:4384
  v_cvt_pk_bf16_f32 v16, v16, v17
  v_cvt_pk_bf16_f32 v17, v18, v19
  ds_write_b64 v104, v[16:17] offset:64
  v_cvt_pk_bf16_f32 v20, v20, v21
  v_cvt_pk_bf16_f32 v21, v22, v23
  ds_write_b64 v104, v[20:21] offset:4416
  v_cvt_pk_bf16_f32 v24, v24, v25
  v_cvt_pk_bf16_f32 v25, v26, v27
  ds_write_b64 v104, v[24:25] offset:96
  v_cvt_pk_bf16_f32 v28, v28, v29
  v_cvt_pk_bf16_f32 v29, v30, v31
  ds_write_b64 v104, v[28:29] offset:4448
  s_waitcnt lgkmcnt(0)
Lfinal_37:
  s_mul_i32 s52, s40, 128
  v_add_u32 v24, s52, v96
  v_mul_u32_u24 v25, 16, v24
  v_lshrrev_b32 v25, 8, v25
  v_mul_u32_u24 v26, 16, v25
  v_sub_u32 v26, v24, v26
  v_lshlrev_b32 v26, 4, v26
  v_mul_u32_u24 v27, 272, v25
  v_add_u32 v0, v27, v26
  v_mul_u32_u24 v27, 2176, v25
  v_add_u32 v2, v27, v26
  v_mul_u32_u24 v27, 2048, v25
  v_add_u32 v4, v27, v26
  buffer_load_dwordx4 v[16:19], v4, s[28:31], 0 offen
  v_add_u32 v24, s52, v96
  v_add_u32 v24, 64, v24
  v_mul_u32_u24 v25, 16, v24
  v_lshrrev_b32 v25, 8, v25
  v_mul_u32_u24 v26, 16, v25
  v_sub_u32 v26, v24, v26
  v_lshlrev_b32 v26, 4, v26
  v_mul_u32_u24 v27, 272, v25
  v_add_u32 v1, v27, v26
  v_mul_u32_u24 v27, 2176, v25
  v_add_u32 v3, v27, v26
  v_mul_u32_u24 v27, 2048, v25
  v_add_u32 v5, v27, v26
  buffer_load_dwordx4 v[20:23], v5, s[28:31], 0 offen
  s_barrier
  ds_read_b128 v[8:11], v0 offset:0
  ds_read_b128 v[12:15], v1 offset:0
  s_waitcnt vmcnt(0)
  s_waitcnt lgkmcnt(1)
  v_lshlrev_b32 v24, 16, v8
  v_and_b32 v25, 0xffff0000, v8
  v_lshlrev_b32 v26, 16, v16
  v_and_b32 v27, 0xffff0000, v16
  v_add_f32 v24, v24, v26
  v_add_f32 v25, v25, v27
  v_cvt_pk_bf16_f32 v8, v24, v25
  v_lshlrev_b32 v24, 16, v8
  v_and_b32 v25, 0xffff0000, v8
  v_add_f32 v28, v24, v25
  v_mul_f32 v29, v24, v24
  v_fmac_f32 v29, v25, v25
  v_lshlrev_b32 v24, 16, v9
  v_and_b32 v25, 0xffff0000, v9
  v_lshlrev_b32 v26, 16, v17
  v_and_b32 v27, 0xffff0000, v17
  v_add_f32 v24, v24, v26
  v_add_f32 v25, v25, v27
  v_cvt_pk_bf16_f32 v9, v24, v25
  v_lshlrev_b32 v24, 16, v9
  v_and_b32 v25, 0xffff0000, v9
  v_add_f32 v28, v28, v24
  v_add_f32 v28, v28, v25
  v_fmac_f32 v29, v24, v24
  v_fmac_f32 v29, v25, v25
  v_lshlrev_b32 v24, 16, v10
  v_and_b32 v25, 0xffff0000, v10
  v_lshlrev_b32 v26, 16, v18
  v_and_b32 v27, 0xffff0000, v18
  v_add_f32 v24, v24, v26
  v_add_f32 v25, v25, v27
  v_cvt_pk_bf16_f32 v10, v24, v25
  v_lshlrev_b32 v24, 16, v10
  v_and_b32 v25, 0xffff0000, v10
  v_add_f32 v28, v28, v24
  v_add_f32 v28, v28, v25
  v_fmac_f32 v29, v24, v24
  v_fmac_f32 v29, v25, v25
  v_lshlrev_b32 v24, 16, v11
  v_and_b32 v25, 0xffff0000, v11
  v_lshlrev_b32 v26, 16, v19
  v_and_b32 v27, 0xffff0000, v19
  v_add_f32 v24, v24, v26
  v_add_f32 v25, v25, v27
  v_cvt_pk_bf16_f32 v11, v24, v25
  v_lshlrev_b32 v24, 16, v11
  v_and_b32 v25, 0xffff0000, v11
  v_add_f32 v28, v28, v24
  v_add_f32 v28, v28, v25
  v_fmac_f32 v29, v24, v24
  v_fmac_f32 v29, v25, v25
  buffer_store_dwordx4 v[8:11], v2, s[24:27], 0 offen sc1
  s_nop 1
  v_add_f32_dpp v30, v28, v28 quad_perm:[1,0,3,2] row_mask:0xf bank_mask:0xf
  v_add_f32_dpp v31, v29, v29 quad_perm:[1,0,3,2] row_mask:0xf bank_mask:0xf
  v_mov_b32 v28, v30
  v_mov_b32 v29, v31
  s_nop 1
  v_add_f32_dpp v30, v28, v28 quad_perm:[2,3,0,1] row_mask:0xf bank_mask:0xf
  v_add_f32_dpp v31, v29, v29 quad_perm:[2,3,0,1] row_mask:0xf bank_mask:0xf
  v_mov_b32 v28, v30
  v_mov_b32 v29, v31
  s_nop 1
  v_add_f32_dpp v30, v28, v28 row_half_mirror row_mask:0xf bank_mask:0xf
  v_add_f32_dpp v31, v29, v29 row_half_mirror row_mask:0xf bank_mask:0xf
  v_mov_b32 v28, v30
  v_mov_b32 v29, v31
  s_nop 1
  v_add_f32_dpp v30, v28, v28 row_mirror row_mask:0xf bank_mask:0xf
  v_add_f32_dpp v31, v29, v29 row_mirror row_mask:0xf bank_mask:0xf
  v_mov_b32 v28, v30
  v_mov_b32 v29, v31
  v_mov_b32 v32, v28
  v_mov_b32 v33, v29
  s_waitcnt lgkmcnt(0)
  v_lshlrev_b32 v24, 16, v12
  v_and_b32 v25, 0xffff0000, v12
  v_lshlrev_b32 v26, 16, v20
  v_and_b32 v27, 0xffff0000, v20
  v_add_f32 v24, v24, v26
  v_add_f32 v25, v25, v27
  v_cvt_pk_bf16_f32 v12, v24, v25
  v_lshlrev_b32 v24, 16, v12
  v_and_b32 v25, 0xffff0000, v12
  v_add_f32 v28, v24, v25
  v_mul_f32 v29, v24, v24
  v_fmac_f32 v29, v25, v25
  v_lshlrev_b32 v24, 16, v13
  v_and_b32 v25, 0xffff0000, v13
  v_lshlrev_b32 v26, 16, v21
  v_and_b32 v27, 0xffff0000, v21
  v_add_f32 v24, v24, v26
  v_add_f32 v25, v25, v27
  v_cvt_pk_bf16_f32 v13, v24, v25
  v_lshlrev_b32 v24, 16, v13
  v_and_b32 v25, 0xffff0000, v13
  v_add_f32 v28, v28, v24
  v_add_f32 v28, v28, v25
  v_fmac_f32 v29, v24, v24
  v_fmac_f32 v29, v25, v25
  v_lshlrev_b32 v24, 16, v14
  v_and_b32 v25, 0xffff0000, v14
  v_lshlrev_b32 v26, 16, v22
  v_and_b32 v27, 0xffff0000, v22
  v_add_f32 v24, v24, v26
  v_add_f32 v25, v25, v27
  v_cvt_pk_bf16_f32 v14, v24, v25
  v_lshlrev_b32 v24, 16, v14
  v_and_b32 v25, 0xffff0000, v14
  v_add_f32 v28, v28, v24
  v_add_f32 v28, v28, v25
  v_fmac_f32 v29, v24, v24
  v_fmac_f32 v29, v25, v25
  v_lshlrev_b32 v24, 16, v15
  v_and_b32 v25, 0xffff0000, v15
  v_lshlrev_b32 v26, 16, v23
  v_and_b32 v27, 0xffff0000, v23
  v_add_f32 v24, v24, v26
  v_add_f32 v25, v25, v27
  v_cvt_pk_bf16_f32 v15, v24, v25
  v_lshlrev_b32 v24, 16, v15
  v_and_b32 v25, 0xffff0000, v15
  v_add_f32 v28, v28, v24
  v_add_f32 v28, v28, v25
  v_fmac_f32 v29, v24, v24
  v_fmac_f32 v29, v25, v25
  buffer_store_dwordx4 v[12:15], v3, s[24:27], 0 offen sc1
  s_nop 1
  v_add_f32_dpp v30, v28, v28 quad_perm:[1,0,3,2] row_mask:0xf bank_mask:0xf
  v_add_f32_dpp v31, v29, v29 quad_perm:[1,0,3,2] row_mask:0xf bank_mask:0xf
  v_mov_b32 v28, v30
  v_mov_b32 v29, v31
  s_nop 1
  v_add_f32_dpp v30, v28, v28 quad_perm:[2,3,0,1] row_mask:0xf bank_mask:0xf
  v_add_f32_dpp v31, v29, v29 quad_perm:[2,3,0,1] row_mask:0xf bank_mask:0xf
  v_mov_b32 v28, v30
  v_mov_b32 v29, v31
  s_nop 1
  v_add_f32_dpp v30, v28, v28 row_half_mirror row_mask:0xf bank_mask:0xf
  v_add_f32_dpp v31, v29, v29 row_half_mirror row_mask:0xf bank_mask:0xf
  v_mov_b32 v28, v30
  v_mov_b32 v29, v31
  s_nop 1
  v_add_f32_dpp v30, v28, v28 row_mirror row_mask:0xf bank_mask:0xf
  v_add_f32_dpp v31, v29, v29 row_mirror row_mask:0xf bank_mask:0xf
  v_mov_b32 v28, v30
  v_mov_b32 v29, v31
  v_and_b32 v26, 1, v96
  v_cmp_eq_u32 vcc, 0, v26
  v_lshrrev_b32 v25, 4, v96
  v_lshl_add_u32 v25, v26, 2, v25
  v_cndmask_b32 v16, v28, v32, vcc
  v_cndmask_b32 v17, v29, v33, vcc
  s_lshl_b32 s53, s40, 3
  v_add_u32 v25, s53, v25
  v_lshlrev_b32 v25, 3, v25
  v_and_b32 v26, 14, v96
  v_cmp_eq_u32 vcc, 0, v26
  v_mov_b32 v27, 0x7fffffff
  s_nop 1
  v_cndmask_b32 v25, v27, v25, vcc
  buffer_store_dwordx2 v[16:17], v25, s[32:35], 0 offen sc1
LT1_48:
LT1p_46:
  s_waitcnt vmcnt(0)
  s_barrier
  s_cmp_lg_u32 s40, 0
  s_cbranch_scc1 Lflag_49
  s_lshl_b32 s52, s41, 3
  s_add_u32 s52, s52, s42
  s_lshl_b32 s52, s52, 6
  s_add_u32 s52, s52, 33619968
  v_lshlrev_b32 v24, 3, v96
  v_add_u32 v24, s52, v24
  v_mov_b32 v116, s72
  v_mov_b32 v117, s73
  s_mov_b64 s[58:59], exec
  s_mov_b64 exec, 0xff
  global_store_dwordx2 v24, v[116:117], s[4:5] sc1
  s_mov_b64 exec, s[58:59]
Lflag_49:
  v_mbcnt_lo_u32_b32 v200, -1, 0
  v_mbcnt_hi_u32_b32 v200, -1, v200
  s_and_b32 s52, s2, 7
  s_lshr_b32 s53, s2, 3
  s_and_b32 s54, s52, 1
  s_lshr_b32 s55, s52, 1
  s_lshl_b32 s41, s54, 3
  s_and_b32 s54, s53, 7
  s_add_u32 s41, s41, s54
  s_lshl_b32 s42, s55, 2
  s_lshr_b32 s54, s53, 3
  s_add_u32 s42, s42, s54
  s_mul_i32 s52, s41, 278528
  s_add_u32 s52, s52, 5242880
  s_add_u32 s12, s4, s52
  s_addc_u32 s13, s5, 0
  s_mov_b32 s16, s12
  s_and_b32 s17, s13, 0xffff
  s_mov_b32 s18, 0x44000
  s_mov_b32 s19, 0x00020000
  s_mul_i32 s52, s42, 448
  s_add_u32 s12, s66, s52
  s_addc_u32 s13, s67, 0
  s_sub_u32 s53, 7340032, s52
  s_mov_b32 s20, s12
  s_and_b32 s21, s13, 0xffff
  s_mov_b32 s22, s53
  s_mov_b32 s23, 0x00020000
  s_cmp_lt_u32 s40, 4
  s_cbranch_scc1 Lconsumer_50
  s_sub_u32 s43, s40, 4
  s_mov_b32 s46, 0
  s_mov_b32 s47, 0
  v_lshrrev_b32 v205, 3, v200
  v_and_b32 v206, 7, v200
  s_mul_i32 s52, s43, 32
  v_add_u32 v207, s52, v205
  v_bfe_u32 v208, v207, 1, 3
  v_xor_b32 v208, v208, v206
  v_lshlrev_b32 v208, 4, v208
  s_mov_b32 s53, 2176
  v_mul_lo_u32 v207, v207, s53
  v_add_u32 v32, v207, v208
  v_add_u32 v207, s52, v205
  v_add_u32 v207, 8, v207
  v_bfe_u32 v208, v207, 1, 3
  v_xor_b32 v208, v208, v206
  v_lshlrev_b32 v208, 4, v208
  s_mov_b32 s53, 2176
  v_mul_lo_u32 v207, v207, s53
  v_add_u32 v33, v207, v208
  v_add_u32 v207, s52, v205
  v_add_u32 v207, 16, v207
  v_bfe_u32 v208, v207, 1, 3
  v_xor_b32 v208, v208, v206
  v_lshlrev_b32 v208, 4, v208
  s_mov_b32 s53, 2176
  v_mul_lo_u32 v207, v207, s53
  v_add_u32 v34, v207, v208
  v_add_u32 v207, s52, v205
  v_add_u32 v207, 24, v207
  v_bfe_u32 v208, v207, 1, 3
  v_xor_b32 v208, v208, v206
  v_lshlrev_b32 v208, 4, v208
  s_mov_b32 s53, 2176
  v_mul_lo_u32 v207, v207, s53
  v_add_u32 v35, v207, v208
  s_mul_i32 s52, s43, 448
  v_add_u32 v205, s52, v200
  v_mul_u32_u24 v206, 2341, v205
  v_lshrrev_b32 v206, 16, v206
  v_mul_u32_u24 v207, 28, v206
  v_sub_u32 v207, v205, v207
  v_bfe_u32 v208, v206, 3, 1
  v_lshlrev_b32 v208, 1, v208
  v_xor_b32 v207, v207, v208
  v_lshlrev_b32 v207, 4, v207
  s_mov_b32 s53, 7168
  v_mul_lo_u32 v206, v206, s53
  v_add_u32 v36, v206, v207
  v_add_u32 v205, s52, v200
  v_add_u32 v205, 64, v205
  v_mul_u32_u24 v206, 2341, v205
  v_lshrrev_b32 v206, 16, v206
  v_mul_u32_u24 v207, 28, v206
  v_sub_u32 v207, v205, v207
  v_bfe_u32 v208, v206, 3, 1
  v_lshlrev_b32 v208, 1, v208
  v_xor_b32 v207, v207, v208
  v_lshlrev_b32 v207, 4, v207
  s_mov_b32 s53, 7168
  v_mul_lo_u32 v206, v206, s53
  v_add_u32 v37, v206, v207
  v_add_u32 v205, s52, v200
  v_add_u32 v205, 128, v205
  v_mul_u32_u24 v206, 2341, v205
  v_lshrrev_b32 v206, 16, v206
  v_mul_u32_u24 v207, 28, v206
  v_sub_u32 v207, v205, v207
  v_bfe_u32 v208, v206, 3, 1
  v_lshlrev_b32 v208, 1, v208
  v_xor_b32 v207, v207, v208
  v_lshlrev_b32 v207, 4, v207
  s_mov_b32 s53, 7168
  v_mul_lo_u32 v206, v206, s53
  v_add_u32 v38, v206, v207
  v_add_u32 v205, s52, v200
  v_add_u32 v205, 192, v205
  v_mul_u32_u24 v206, 2341, v205
  v_lshrrev_b32 v206, 16, v206
  v_mul_u32_u24 v207, 28, v206
  v_sub_u32 v207, v205, v207
  v_bfe_u32 v208, v206, 3, 1
  v_lshlrev_b32 v208, 1, v208
  v_xor_b32 v207, v207, v208
  v_lshlrev_b32 v207, 4, v207
  s_mov_b32 s53, 7168
  v_mul_lo_u32 v206, v206, s53
  v_add_u32 v39, v206, v207
  v_add_u32 v205, s52, v200
  v_add_u32 v205, 256, v205
  v_mul_u32_u24 v206, 2341, v205
  v_lshrrev_b32 v206, 16, v206
  v_mul_u32_u24 v207, 28, v206
  v_sub_u32 v207, v205, v207
  v_bfe_u32 v208, v206, 3, 1
  v_lshlrev_b32 v208, 1, v208
  v_xor_b32 v207, v207, v208
  v_lshlrev_b32 v207, 4, v207
  s_mov_b32 s53, 7168
  v_mul_lo_u32 v206, v206, s53
  v_add_u32 v40, v206, v207
  v_add_u32 v205, s52, v200
  v_add_u32 v205, 320, v205
  v_mul_u32_u24 v206, 2341, v205
  v_lshrrev_b32 v206, 16, v206
  v_mul_u32_u24 v207, 28, v206
  v_sub_u32 v207, v205, v207
  v_bfe_u32 v208, v206, 3, 1
  v_lshlrev_b32 v208, 1, v208
  v_xor_b32 v207, v207, v208
  v_lshlrev_b32 v207, 4, v207
  s_mov_b32 s53, 7168
  v_mul_lo_u32 v206, v206, s53
  v_add_u32 v41, v206, v207
  v_add_u32 v205, s52, v200
  v_add_u32 v205, 384, v205
  v_mul_u32_u24 v206, 2341, v205
  v_lshrrev_b32 v206, 16, v206
  v_mul_u32_u24 v207, 28, v206
  v_sub_u32 v207, v205, v207
  v_bfe_u32 v208, v206, 3, 1
  v_lshlrev_b32 v208, 1, v208
  v_xor_b32 v207, v207, v208
  v_lshlrev_b32 v207, 4, v207
  s_mov_b32 s53, 7168
  v_mul_lo_u32 v206, v206, s53
  v_add_u32 v42, v206, v207
  s_mul_i32 s48, s43, 4096
  s_mul_i32 s49, s43, 7168
  s_add_u32 s49, s49, 65536
  s_mov_b32 s45, 0
  s_mov_b32 s51, 0
  s_add_u32 m0, s51, s49
  s_nop 0
  buffer_load_dwordx4 v36, s[20:23], s47 offen lds
  s_add_u32 m0, m0, 0x400
  s_nop 0
  buffer_load_dwordx4 v37, s[20:23], s47 offen lds
  s_add_u32 m0, m0, 0x400
  s_nop 0
  buffer_load_dwordx4 v38, s[20:23], s47 offen lds
  s_add_u32 m0, m0, 0x400
  s_nop 0
  buffer_load_dwordx4 v39, s[20:23], s47 offen lds
  s_add_u32 m0, m0, 0x400
  s_nop 0
  buffer_load_dwordx4 v40, s[20:23], s47 offen lds
  s_add_u32 m0, m0, 0x400
  s_nop 0
  buffer_load_dwordx4 v41, s[20:23], s47 offen lds
  s_add_u32 m0, m0, 0x400
  s_nop 0
  buffer_load_dwordx4 v42, s[20:23], s47 offen lds
  s_add_u32 s51, s51, 28672
  s_cmp_eq_u32 s51, 86016
  s_cselect_b32 s51, 0, s51
  s_add_u32 s47, s47, 458752
  s_add_u32 m0, s51, s49
  s_nop 0
  buffer_load_dwordx4 v36, s[20:23], s47 offen lds
  s_add_u32 m0, m0, 0x400
  s_nop 0
  buffer_load_dwordx4 v37, s[20:23], s47 offen lds
  s_add_u32 m0, m0, 0x400
  s_nop 0
  buffer_load_dwordx4 v38, s[20:23], s47 offen lds
  s_add_u32 m0, m0, 0x400
  s_nop 0
  buffer_load_dwordx4 v39, s[20:23], s47 offen lds
  s_add_u32 m0, m0, 0x400
  s_nop 0
  buffer_load_dwordx4 v40, s[20:23], s47 offen lds
  s_add_u32 m0, m0, 0x400
  s_nop 0
  buffer_load_dwordx4 v41, s[20:23], s47 offen lds
  s_add_u32 m0, m0, 0x400
  s_nop 0
  buffer_load_dwordx4 v42, s[20:23], s47 offen lds
  s_add_u32 s51, s51, 28672
  s_cmp_eq_u32 s51, 86016
  s_cselect_b32 s51, 0, s51
  s_add_u32 s47, s47, 458752
  s_cmp_lg_u32 s40, 4
  s_cbranch_scc1 Lnopoll_52
  s_lshl_b32 s52, s41, 10
  s_add_u32 s52, s52, 33619968
  v_and_b32 v205, 15, v200
  v_lshlrev_b32 v205, 6, v205
  v_add_u32 v205, s52, v205
  v_mov_b32 v56, s72
  v_mov_b32 v57, s73
  s_mov_b32 s57, 0
Lpoll_53:
  global_load_dwordx2 v[58:59], v205, s[4:5] sc1
  s_waitcnt vmcnt(0)
  v_cmp_eq_u64 vcc, v[56:57], v[58:59]
  s_nop 4
  s_cmp_eq_u64 vcc, exec
  s_cbranch_scc1 Lpolld_54
  s_add_u32 s57, s57, 1
  s_cmp_gt_u32 s57, 0x40000
  s_cbranch_scc1 Lpolld_54
  s_sleep 4
  s_branch Lpoll_53
Lpolld_54:
  s_mul_i32 s52, s42, 224
  s_lshr_b32 s52, s52, 6
  v_lshrrev_b32 v205, 2, v200
  v_mul_u32_u24 v205, 56, v205
  v_and_b32 v206, 3, v200
  v_add3_u32 v205, v205, v206, s52
  v_lshlrev_b32 v205, 6, v205
  v_add_u32 v205, 33816576, v205
  s_mov_b32 s57, 0
Lcs_55:
  global_load_dwordx2 v[58:59], v205, s[4:5] sc1
  s_waitcnt vmcnt(0)
  v_cmp_eq_u64 vcc, v[56:57], v[58:59]
  s_nop 4
  s_cmp_eq_u64 vcc, exec
  s_cbranch_scc1 Lcsd_56
  s_add_u32 s57, s57, 1
  s_cmp_gt_u32 s57, 0x40000
  s_cbranch_scc1 Lcsd_56
  s_sleep 4
  s_branch Lcs_55
Lcsd_56:
Lnopoll_52:
  s_barrier
  s_add_u32 m0, s45, s48
  s_nop 0
  buffer_load_dwordx4 v32, s[16:19], s46 offen sc1 lds
  s_add_u32 m0, m0, 0x400
  s_nop 0
  buffer_load_dwordx4 v33, s[16:19], s46 offen sc1 lds
  s_add_u32 m0, m0, 0x400
  s_nop 0
  buffer_load_dwordx4 v34, s[16:19], s46 offen sc1 lds
  s_add_u32 m0, m0, 0x400
  s_nop 0
  buffer_load_dwordx4 v35, s[16:19], s46 offen sc1 lds
  s_add_u32 s45, s45, 16384
  s_cmp_eq_u32 s45, 65536
  s_cselect_b32 s45, 0, s45
  s_add_u32 s46, s46, 128
  s_add_u32 m0, s45, s48
  s_nop 0
  buffer_load_dwordx4 v32, s[16:19], s46 offen sc1 lds
  s_add_u32 m0, m0, 0x400
  s_nop 0
  buffer_load_dwordx4 v33, s[16:19], s46 offen sc1 lds
  s_add_u32 m0, m0, 0x400
  s_nop 0
  buffer_load_dwordx4 v34, s[16:19], s46 offen sc1 lds
  s_add_u32 m0, m0, 0x400
  s_nop 0
  buffer_load_dwordx4 v35, s[16:19], s46 offen sc1 lds
  s_add_u32 s45, s45, 16384
  s_cmp_eq_u32 s45, 65536
  s_cselect_b32 s45, 0, s45
  s_add_u32 s46, s46, 128
  s_add_u32 m0, s45, s48
  s_nop 0
  buffer_load_dwordx4 v32, s[16:19], s46 offen sc1 lds
  s_add_u32 m0, m0, 0x400
  s_nop 0
  buffer_load_dwordx4 v33, s[16:19], s46 offen sc1 lds
  s_add_u32 m0, m0, 0x400
  s_nop 0
  buffer_load_dwordx4 v34, s[16:19], s46 offen sc1 lds
  s_add_u32 m0, m0, 0x400
  s_nop 0
  buffer_load_dwordx4 v35, s[16:19], s46 offen sc1 lds
  s_add_u32 s45, s45, 16384
  s_cmp_eq_u32 s45, 65536
  s_cselect_b32 s45, 0, s45
  s_add_u32 s46, s46, 128
  s_waitcnt vmcnt(8)
  s_barrier
  s_add_u32 m0, s45, s48
  s_nop 0
  buffer_load_dwordx4 v32, s[16:19], s46 offen sc1 lds
  s_add_u32 m0, m0, 0x400
  s_nop 0
  buffer_load_dwordx4 v33, s[16:19], s46 offen sc1 lds
  s_add_u32 m0, m0, 0x400
  s_nop 0
  buffer_load_dwordx4 v34, s[16:19], s46 offen sc1 lds
  s_add_u32 m0, m0, 0x400
  s_nop 0
  buffer_load_dwordx4 v35, s[16:19], s46 offen sc1 lds
  s_add_u32 s45, s45, 16384
  s_cmp_eq_u32 s45, 65536
  s_cselect_b32 s45, 0, s45
  s_add_u32 s46, s46, 128
  s_add_u32 m0, s51, s49
  s_nop 0
  buffer_load_dwordx4 v36, s[20:23], s47 offen lds
  s_add_u32 m0, m0, 0x400
  s_nop 0
  buffer_load_dwordx4 v37, s[20:23], s47 offen lds
  s_add_u32 m0, m0, 0x400
  s_nop 0
  buffer_load_dwordx4 v38, s[20:23], s47 offen lds
  s_add_u32 m0, m0, 0x400
  s_nop 0
  buffer_load_dwordx4 v39, s[20:23], s47 offen lds
  s_add_u32 m0, m0, 0x400
  s_nop 0
  buffer_load_dwordx4 v40, s[20:23], s47 offen lds
  s_add_u32 m0, m0, 0x400
  s_nop 0
  buffer_load_dwordx4 v41, s[20:23], s47 offen lds
  s_add_u32 m0, m0, 0x400
  s_nop 0
  buffer_load_dwordx4 v42, s[20:23], s47 offen lds
  s_add_u32 s51, s51, 28672
  s_cmp_eq_u32 s51, 86016
  s_cselect_b32 s51, 0, s51
  s_add_u32 s47, s47, 458752
  s_waitcnt vmcnt(15)
  s_barrier
  s_add_u32 m0, s45, s48
  s_nop 0
  buffer_load_dwordx4 v32, s[16:19], s46 offen sc1 lds
  s_add_u32 m0, m0, 0x400
  s_nop 0
  buffer_load_dwordx4 v33, s[16:19], s46 offen sc1 lds
  s_add_u32 m0, m0, 0x400
  s_nop 0
  buffer_load_dwordx4 v34, s[16:19], s46 offen sc1 lds
  s_add_u32 m0, m0, 0x400
  s_nop 0
  buffer_load_dwordx4 v35, s[16:19], s46 offen sc1 lds
  s_add_u32 s45, s45, 16384
  s_cmp_eq_u32 s45, 65536
  s_cselect_b32 s45, 0, s45
  s_add_u32 s46, s46, 128
  s_add_u32 m0, s51, s49
  s_nop 0
  buffer_load_dwordx4 v36, s[20:23], s47 offen lds
  s_add_u32 m0, m0, 0x400
  s_nop 0
  buffer_load_dwordx4 v37, s[20:23], s47 offen lds
  s_add_u32 m0, m0, 0x400
  s_nop 0
  buffer_load_dwordx4 v38, s[20:23], s47 offen lds
  s_add_u32 m0, m0, 0x400
  s_nop 0
  buffer_load_dwordx4 v39, s[20:23], s47 offen lds
  s_add_u32 m0, m0, 0x400
  s_nop 0
  buffer_load_dwordx4 v40, s[20:23], s47 offen lds
  s_add_u32 m0, m0, 0x400
  s_nop 0
  buffer_load_dwordx4 v41, s[20:23], s47 offen lds
  s_add_u32 m0, m0, 0x400
  s_nop 0
  buffer_load_dwordx4 v42, s[20:23], s47 offen lds
  s_add_u32 s51, s51, 28672
  s_cmp_eq_u32 s51, 86016
  s_cselect_b32 s51, 0, s51
  s_add_u32 s47, s47, 458752
  s_mov_b32 s50, 0
Lprod_57:
  s_waitcnt vmcnt(11)
  s_barrier
  s_add_u32 m0, s45, s48
  s_nop 0
  buffer_load_dwordx4 v32, s[16:19], s46 offen sc1 lds
  s_add_u32 m0, m0, 0x400
  s_nop 0
  buffer_load_dwordx4 v33, s[16:19], s46 offen sc1 lds
  s_add_u32 m0, m0, 0x400
  s_nop 0
  buffer_load_dwordx4 v34, s[16:19], s46 offen sc1 lds
  s_add_u32 m0, m0, 0x400
  s_nop 0
  buffer_load_dwordx4 v35, s[16:19], s46 offen sc1 lds
  s_add_u32 s45, s45, 16384
  s_cmp_eq_u32 s45, 65536
  s_cselect_b32 s45, 0, s45
  s_add_u32 s46, s46, 128
  s_add_u32 m0, s51, s49
  s_nop 0
  buffer_load_dwordx4 v36, s[20:23], s47 offen lds
  s_add_u32 m0, m0, 0x400
  s_nop 0
  buffer_load_dwordx4 v37, s[20:23], s47 offen lds
  s_add_u32 m0, m0, 0x400
  s_nop 0
  buffer_load_dwordx4 v38, s[20:23], s47 offen lds
  s_add_u32 m0, m0, 0x400
  s_nop 0
  buffer_load_dwordx4 v39, s[20:23], s47 offen lds
  s_add_u32 m0, m0, 0x400
  s_nop 0
  buffer_load_dwordx4 v40, s[20:23], s47 offen lds
  s_add_u32 m0, m0, 0x400
  s_nop 0
  buffer_load_dwordx4 v41, s[20:23], s47 offen lds
  s_add_u32 m0, m0, 0x400
  s_nop 0
  buffer_load_dwordx4 v42, s[20:23], s47 offen lds
  s_add_u32 s51, s51, 28672
  s_cmp_eq_u32 s51, 86016
  s_cselect_b32 s51, 0, s51
  s_add_u32 s47, s47, 458752
  s_add_u32 s50, s50, 1
  s_cmp_lt_u32 s50, 11
  s_cbranch_scc1 Lprod_57
  s_waitcnt vmcnt(11)
  s_barrier
  s_add_u32 m0, s51, s49
  s_nop 0
  buffer_load_dwordx4 v36, s[20:23], s47 offen lds
  s_add_u32 m0, m0, 0x400
  s_nop 0
  buffer_load_dwordx4 v37, s[20:23], s47 offen lds
  s_add_u32 m0, m0, 0x400
  s_nop 0
  buffer_load_dwordx4 v38, s[20:23], s47 offen lds
  s_add_u32 m0, m0, 0x400
  s_nop 0
  buffer_load_dwordx4 v39, s[20:23], s47 offen lds
  s_add_u32 m0, m0, 0x400
  s_nop 0
  buffer_load_dwordx4 v40, s[20:23], s47 offen lds
  s_add_u32 m0, m0, 0x400
  s_nop 0
  buffer_load_dwordx4 v41, s[20:23], s47 offen lds
  s_add_u32 m0, m0, 0x400
  s_nop 0
  buffer_load_dwordx4 v42, s[20:23], s47 offen lds
  s_add_u32 s51, s51, 28672
  s_cmp_eq_u32 s51, 86016
  s_cselect_b32 s51, 0, s51
  s_add_u32 s47, s47, 458752
  s_waitcnt vmcnt(7)
  s_barrier
  s_waitcnt vmcnt(0)
  s_barrier
  s_mul_i32 s52, s41, 933888
  s_mul_i32 s53, s42, 448
  s_add_u32 s52, s52, s53
  s_add_u32 s54, s52, 10485760
  s_add_u32 s12, s4, s54
  s_addc_u32 s13, s5, 0
  s_sub_u32 s53, 14942208, s52
  s_mov_b32 s24, s12
  s_and_b32 s25, s13, 0xffff
  s_mov_b32 s26, s53
  s_mov_b32 s27, 0x00020000
  s_mul_i32 s52, s41, 8192
  s_add_u32 s52, s52, 30408704
  s_add_u32 s12, s4, s52
  s_addc_u32 s13, s5, 0
  s_mov_b32 s32, s12
  s_and_b32 s33, s13, 0xffff
  s_mov_b32 s34, 0x2000
  s_mov_b32 s35, 0x00020000
  s_mul_i32 s52, s42, 896
  s_add_u32 s52, s52, 31457280
  s_add_u32 s12, s4, s52
  s_addc_u32 s13, s5, 0
  s_mov_b32 s36, s12
  s_and_b32 s37, s13, 0xffff
  s_mov_b32 s38, 0x34b80
  s_mov_b32 s39, 0x00020000
  s_barrier
  s_branch Lfinal_51
Lconsumer_50:
  s_lshr_b32 s43, s40, 1
  s_and_b32 s44, s40, 1
  s_mul_i32 s52, s41, 933888
  s_mul_i32 s53, s42, 448
  s_add_u32 s52, s52, s53
  s_add_u32 s54, s52, 10485760
  s_add_u32 s12, s4, s54
  s_addc_u32 s13, s5, 0
  s_sub_u32 s53, 14942208, s52
  s_mov_b32 s24, s12
  s_and_b32 s25, s13, 0xffff
  s_mov_b32 s26, s53
  s_mov_b32 s27, 0x00020000
  s_mul_i32 s52, s41, 8192
  s_add_u32 s52, s52, 30408704
  s_add_u32 s12, s4, s52
  s_addc_u32 s13, s5, 0
  s_mov_b32 s32, s12
  s_and_b32 s33, s13, 0xffff
  s_mov_b32 s34, 0x2000
  s_mov_b32 s35, 0x00020000
  s_mul_i32 s52, s42, 896
  s_add_u32 s52, s52, 31457280
  s_add_u32 s12, s4, s52
  s_addc_u32 s13, s5, 0
  s_mov_b32 s36, s12
  s_and_b32 s37, s13, 0xffff
  s_mov_b32 s38, 0x34b80
  s_mov_b32 s39, 0x00020000
  v_and_b32 v205, 15, v200
  v_lshrrev_b32 v206, 4, v200
  v_lshrrev_b32 v207, 1, v205
  s_mul_i32 s52, s43, 64
  v_add_u32 v208, s52, v205
  v_lshlrev_b32 v208, 7, v208
  v_xor_b32 v207, v207, v206
  v_lshl_add_u32 v201, v207, 4, v208
  v_xor_b32 v207, 4, v207
  v_lshl_add_u32 v202, v207, 4, v208
  v_lshrrev_b32 v207, 2, v205
  v_lshl_add_u32 v208, v206, 3, v207
  v_mov_b32 v209, 0
  v_bfe_u32 v210, v208, 3, 1
  v_lshlrev_b32 v210, 0, v210
  v_or_b32 v209, v209, v210
  v_mul_u32_u24 v208, 448, v208
  v_and_b32 v207, 3, v205
  v_lshl_add_u32 v208, v207, 3, v208
  v_add_u32 v208, 65536, v208
  s_mul_i32 s52, s44, 7
  s_add_u32 s53, s52, 0
  v_xor_b32 v207, s53, v209
  v_lshl_add_u32 v203, v207, 5, v208
  s_add_u32 s53, s52, 1
  v_xor_b32 v207, s53, v209
  v_lshl_add_u32 v204, v207, 5, v208
  v_subrev_u32 v204, 32, v204
  s_barrier
  v_mov_b32 v0, 0
  v_mov_b32 v1, 0
  v_mov_b32 v2, 0
  v_mov_b32 v3, 0
  v_mov_b32 v4, 0
  v_mov_b32 v5, 0
  v_mov_b32 v6, 0
  v_mov_b32 v7, 0
  v_mov_b32 v8, 0
  v_mov_b32 v9, 0
  v_mov_b32 v10, 0
  v_mov_b32 v11, 0
  v_mov_b32 v12, 0
  v_mov_b32 v13, 0
  v_mov_b32 v14, 0
  v_mov_b32 v15, 0
  v_mov_b32 v16, 0
  v_mov_b32 v17, 0
  v_mov_b32 v18, 0
  v_mov_b32 v19, 0
  v_mov_b32 v20, 0
  v_mov_b32 v21, 0
  v_mov_b32 v22, 0
  v_mov_b32 v23, 0
  v_mov_b32 v24, 0
  v_mov_b32 v25, 0
  v_mov_b32 v26, 0
  v_mov_b32 v27, 0
  v_mov_b32 v28, 0
  v_mov_b32 v29, 0
  v_mov_b32 v30, 0
  v_mov_b32 v31, 0
  v_mov_b32 v32, 0
  v_mov_b32 v33, 0
  v_mov_b32 v34, 0
  v_mov_b32 v35, 0
  v_mov_b32 v36, 0
  v_mov_b32 v37, 0
  v_mov_b32 v38, 0
  v_mov_b32 v39, 0
  v_mov_b32 v40, 0
  v_mov_b32 v41, 0
  v_mov_b32 v42, 0
  v_mov_b32 v43, 0
  v_mov_b32 v44, 0
  v_mov_b32 v45, 0
  v_mov_b32 v46, 0
  v_mov_b32 v47, 0
  v_mov_b32 v48, 0
  v_mov_b32 v49, 0
  v_mov_b32 v50, 0
  v_mov_b32 v51, 0
  v_mov_b32 v52, 0
  v_mov_b32 v53, 0
  v_mov_b32 v54, 0
  v_mov_b32 v55, 0
  v_mov_b32 v56, 0
  v_mov_b32 v57, 0
  v_mov_b32 v58, 0
  v_mov_b32 v59, 0
  v_mov_b32 v60, 0
  v_mov_b32 v61, 0
  v_mov_b32 v62, 0
  v_mov_b32 v63, 0
  v_mov_b32 v64, 0
  v_mov_b32 v65, 0
  v_mov_b32 v66, 0
  v_mov_b32 v67, 0
  v_mov_b32 v68, 0
  v_mov_b32 v69, 0
  v_mov_b32 v70, 0
  v_mov_b32 v71, 0
  v_mov_b32 v72, 0
  v_mov_b32 v73, 0
  v_mov_b32 v74, 0
  v_mov_b32 v75, 0
  v_mov_b32 v76, 0
  v_mov_b32 v77, 0
  v_mov_b32 v78, 0
  v_mov_b32 v79, 0
  v_mov_b32 v80, 0
  v_mov_b32 v81, 0
  v_mov_b32 v82, 0
  v_mov_b32 v83, 0
  v_mov_b32 v84, 0
  v_mov_b32 v85, 0
  v_mov_b32 v86, 0
  v_mov_b32 v87, 0
  v_mov_b32 v88, 0
  v_mov_b32 v89, 0
  v_mov_b32 v90, 0
  v_mov_b32 v91, 0
  v_mov_b32 v92, 0
  v_mov_b32 v93, 0
  v_mov_b32 v94, 0
  v_mov_b32 v95, 0
  v_mov_b32 v96, 0
  v_mov_b32 v97, 0
  v_mov_b32 v98, 0
  v_mov_b32 v99, 0
  v_mov_b32 v100, 0
  v_mov_b32 v101, 0
  v_mov_b32 v102, 0
  v_mov_b32 v103, 0
  v_mov_b32 v104, 0
  v_mov_b32 v105, 0
  v_mov_b32 v106, 0
  v_mov_b32 v107, 0
  v_mov_b32 v108, 0
  v_mov_b32 v109, 0
  v_mov_b32 v110, 0
  v_mov_b32 v111, 0
  s_mov_b32 s45, 0
  s_mov_b32 s51, 0
  s_barrier
  ds_read_b64_tr_b16 v[128:129], v203 offset:0
  ds_read_b64_tr_b16 v[130:131], v203 offset:1792
  ds_read_b128 v[112:115], v201 offset:0
  ds_read_b128 v[116:119], v201 offset:2048
  ds_read_b128 v[120:123], v201 offset:4096
  ds_read_b128 v[124:127], v201 offset:6144
  ds_read_b64_tr_b16 v[132:133], v204 offset:32
  ds_read_b64_tr_b16 v[134:135], v204 offset:1824
  ds_read_b64_tr_b16 v[136:137], v203 offset:64
  ds_read_b64_tr_b16 v[138:139], v203 offset:1856
  ds_read_b64_tr_b16 v[140:141], v204 offset:96
  ds_read_b64_tr_b16 v[142:143], v204 offset:1888
  ds_read_b64_tr_b16 v[144:145], v203 offset:128
  ds_read_b64_tr_b16 v[146:147], v203 offset:1920
  ds_read_b64_tr_b16 v[148:149], v204 offset:160
  ds_read_b64_tr_b16 v[150:151], v204 offset:1952
  ds_read_b64_tr_b16 v[152:153], v203 offset:192
  ds_read_b64_tr_b16 v[154:155], v203 offset:1984
  v_and_b32 v205, 31, v200
  s_lshl_b32 s52, s40, 5
  v_add_u32 v205, s52, v205
  v_lshrrev_b32 v206, 6, v205
  v_lshlrev_b32 v206, 12, v206
  v_and_b32 v207, 63, v205
  v_lshl_add_u32 v206, v207, 3, v206
  v_lshrrev_b32 v207, 5, v200
  v_lshl_add_u32 v206, v207, 11, v206
  buffer_load_dwordx2 v[216:217], v206, s[32:35], 0 offen offset:0 sc1
  buffer_load_dwordx2 v[218:219], v206, s[32:35], 0 offen offset:512 sc1
  buffer_load_dwordx2 v[220:221], v206, s[32:35], 0 offen offset:1024 sc1
  buffer_load_dwordx2 v[222:223], v206, s[32:35], 0 offen offset:1536 sc1
  s_mul_i32 s52, s40, 56
  v_add_u32 v208, s52, v200
  v_lshlrev_b32 v209, 2, v208
  v_cmp_gt_u32 vcc, 56, v200
  v_mov_b32 v210, 0x7fffffff
  s_nop 0
  v_cndmask_b32 v209, v210, v209, vcc
  s_mov_b32 s53, 0
  buffer_load_dword v224, v209, s[36:39], s53 offen sc1
  s_mov_b32 s53, 14336
  buffer_load_dword v225, v209, s[36:39], s53 offen sc1
  s_mov_b32 s53, 28672
  buffer_load_dword v226, v209, s[36:39], s53 offen sc1
  s_mov_b32 s53, 43008
  buffer_load_dword v227, v209, s[36:39], s53 offen sc1
  s_mov_b32 s53, 57344
  buffer_load_dword v228, v209, s[36:39], s53 offen sc1
  s_mov_b32 s53, 71680
  buffer_load_dword v229, v209, s[36:39], s53 offen sc1
  s_mov_b32 s53, 86016
  buffer_load_dword v230, v209, s[36:39], s53 offen sc1
  s_mov_b32 s53, 100352
  buffer_load_dword v231, v209, s[36:39], s53 offen sc1
  s_mov_b32 s53, 114688
  buffer_load_dword v232, v209, s[36:39], s53 offen sc1
  s_mov_b32 s53, 129024
  buffer_load_dword v233, v209, s[36:39], s53 offen sc1
  s_mov_b32 s53, 143360
  buffer_load_dword v234, v209, s[36:39], s53 offen sc1
  s_mov_b32 s53, 157696
  buffer_load_dword v235, v209, s[36:39], s53 offen sc1
  s_mov_b32 s53, 172032
  buffer_load_dword v236, v209, s[36:39], s53 offen sc1
  s_mov_b32 s53, 186368
  buffer_load_dword v237, v209, s[36:39], s53 offen sc1
  s_mov_b32 s53, 200704
  buffer_load_dword v238, v209, s[36:39], s53 offen sc1
  s_mov_b32 s53, 215040
  buffer_load_dword v239, v209, s[36:39], s53 offen sc1
  s_mov_b32 s50, 0
Lcons_59:
  s_waitcnt lgkmcnt(0)
  v_mfma_f32_16x16x32_bf16 v[0:3], v[128:131], v[112:115], v[0:3]
  ds_read_b64_tr_b16 v[172:173], v203 offset:14336
  v_mfma_f32_16x16x32_bf16 v[4:7], v[128:131], v[116:119], v[4:7]
  ds_read_b64_tr_b16 v[174:175], v203 offset:16128
  v_mfma_f32_16x16x32_bf16 v[8:11], v[128:131], v[120:123], v[8:11]
  ds_read_b128 v[156:159], v202 offset:0
  v_mfma_f32_16x16x32_bf16 v[12:15], v[128:131], v[124:127], v[12:15]
  ds_read_b128 v[160:163], v202 offset:2048
  v_mfma_f32_16x16x32_bf16 v[16:19], v[132:135], v[112:115], v[16:19]
  ds_read_b128 v[164:167], v202 offset:4096
  v_mfma_f32_16x16x32_bf16 v[20:23], v[132:135], v[116:119], v[20:23]
  ds_read_b128 v[168:171], v202 offset:6144
  v_mfma_f32_16x16x32_bf16 v[24:27], v[132:135], v[120:123], v[24:27]
  ds_read_b64_tr_b16 v[176:177], v204 offset:14368
  v_mfma_f32_16x16x32_bf16 v[28:31], v[132:135], v[124:127], v[28:31]
  ds_read_b64_tr_b16 v[178:179], v204 offset:16160
  v_mfma_f32_16x16x32_bf16 v[32:35], v[136:139], v[112:115], v[32:35]
  ds_read_b64_tr_b16 v[180:181], v203 offset:14400
  v_mfma_f32_16x16x32_bf16 v[36:39], v[136:139], v[116:119], v[36:39]
  ds_read_b64_tr_b16 v[182:183], v203 offset:16192
  v_mfma_f32_16x16x32_bf16 v[40:43], v[136:139], v[120:123], v[40:43]
  ds_read_b64_tr_b16 v[184:185], v204 offset:14432
  v_mfma_f32_16x16x32_bf16 v[44:47], v[136:139], v[124:127], v[44:47]
  ds_read_b64_tr_b16 v[186:187], v204 offset:16224
  v_mfma_f32_16x16x32_bf16 v[48:51], v[140:143], v[112:115], v[48:51]
  ds_read_b64_tr_b16 v[188:189], v203 offset:14464
  v_mfma_f32_16x16x32_bf16 v[52:55], v[140:143], v[116:119], v[52:55]
  ds_read_b64_tr_b16 v[190:191], v203 offset:16256
  v_mfma_f32_16x16x32_bf16 v[56:59], v[140:143], v[120:123], v[56:59]
  ds_read_b64_tr_b16 v[192:193], v204 offset:14496
  v_mfma_f32_16x16x32_bf16 v[60:63], v[140:143], v[124:127], v[60:63]
  ds_read_b64_tr_b16 v[194:195], v204 offset:16288
  v_mfma_f32_16x16x32_bf16 v[64:67], v[144:147], v[112:115], v[64:67]
  ds_read_b64_tr_b16 v[196:197], v203 offset:14528
  v_mfma_f32_16x16x32_bf16 v[68:71], v[144:147], v[116:119], v[68:71]
  ds_read_b64_tr_b16 v[198:199], v203 offset:16320
  v_mfma_f32_16x16x32_bf16 v[72:75], v[144:147], v[120:123], v[72:75]
  v_mfma_f32_16x16x32_bf16 v[76:79], v[144:147], v[124:127], v[76:79]
  v_mfma_f32_16x16x32_bf16 v[80:83], v[148:151], v[112:115], v[80:83]
  v_mfma_f32_16x16x32_bf16 v[84:87], v[148:151], v[116:119], v[84:87]
  v_mfma_f32_16x16x32_bf16 v[88:91], v[148:151], v[120:123], v[88:91]
  v_mfma_f32_16x16x32_bf16 v[92:95], v[148:151], v[124:127], v[92:95]
  v_mfma_f32_16x16x32_bf16 v[96:99], v[152:155], v[112:115], v[96:99]
  v_mfma_f32_16x16x32_bf16 v[100:103], v[152:155], v[116:119], v[100:103]
  v_mfma_f32_16x16x32_bf16 v[104:107], v[152:155], v[120:123], v[104:107]
  v_mfma_f32_16x16x32_bf16 v[108:111], v[152:155], v[124:127], v[108:111]
  s_waitcnt lgkmcnt(0)
  s_barrier
  s_add_u32 s45, s45, 16384
  s_mov_b32 s46, 16384
  s_cmp_eq_u32 s45, 65536
  s_cselect_b32 s45, 0, s45
  s_cselect_b32 s46, -49152, s46
  s_add_u32 s51, s51, 28672
  s_mov_b32 s47, 28672
  s_cmp_eq_u32 s51, 86016
  s_cselect_b32 s51, 0, s51
  s_cselect_b32 s47, -57344, s47
  v_add_u32 v201, s46, v201
  v_add_u32 v202, s46, v202
  v_add_u32 v203, s47, v203
  v_add_u32 v204, s47, v204
  s_cmp_lg_u32 s50, 6
  s_cbranch_scc1 Lsc_60
  s_waitcnt vmcnt(0)
  v_add_f32 v210, v216, v218
  v_add_f32 v211, v217, v219
  v_add_f32 v210, v210, v220
  v_add_f32 v211, v211, v221
  v_add_f32 v210, v210, v222
  v_add_f32 v211, v211, v223
  v_mov_b32 v216, v210
  v_mov_b32 v217, v211
  v_add_f32 v224, v224, v225
  v_add_f32 v224, v224, v226
  v_add_f32 v224, v224, v227
  v_add_f32 v224, v224, v228
  v_add_f32 v224, v224, v229
  v_add_f32 v224, v224, v230
  v_add_f32 v224, v224, v231
  v_add_f32 v224, v224, v232
  v_add_f32 v224, v224, v233
  v_add_f32 v224, v224, v234
  v_add_f32 v224, v224, v235
  v_add_f32 v224, v224, v236
  v_add_f32 v224, v224, v237
  v_add_f32 v224, v224, v238
  v_add_f32 v224, v224, v239
  v_permlane32_swap_b32 v216, v210
  v_permlane32_swap_b32 v217, v211
  v_add_f32 v210, v210, v216
  v_add_f32 v211, v211, v217
  v_mul_f32 v210, 0x3a800000, v210
  v_mul_f32 v211, 0x3a800000, v211
  v_fma_f32 v211, -v210, v210, v211
  v_max_f32 v211, 0, v211
  v_cvt_pk_bf16_f32 v211, v211, v211
  v_lshlrev_b32 v211, 16, v211
  v_add_f32 v211, 0x3727c5ac, v211
  v_cvt_pk_bf16_f32 v211, v211, v211
  v_lshlrev_b32 v211, 16, v211
  v_sqrt_f32 v211, v211
  s_nop 0
  v_cvt_pk_bf16_f32 v211, v211, v211
  v_lshlrev_b32 v211, 16, v211
  v_rcp_f32 v217, v211
  v_cvt_pk_bf16_f32 v210, v210, v210
  v_lshlrev_b32 v210, 16, v210
  v_sub_f32 v216, 0, v210
  v_and_b32 v205, 31, v200
  s_lshl_b32 s52, s40, 5
  v_add_u32 v205, s52, v205
  v_lshlrev_b32 v205, 3, v205
  v_add_u32 v205, 151552, v205
  ds_write_b64 v205, v[216:217]
  s_mul_i32 s52, s40, 56
  v_add_u32 v208, s52, v200
  v_lshlrev_b32 v208, 2, v208
  v_add_u32 v208, 152576, v208
  v_cmp_gt_u32 vcc, 56, v200
  s_and_saveexec_b64 s[56:57], vcc
  ds_write_b32 v208, v224
  s_mov_b64 exec, s[56:57]
Lsc_60:
  v_mfma_f32_16x16x32_bf16 v[0:3], v[172:175], v[156:159], v[0:3]
  ds_read_b64_tr_b16 v[128:129], v203 offset:0
  v_mfma_f32_16x16x32_bf16 v[4:7], v[172:175], v[160:163], v[4:7]
  ds_read_b64_tr_b16 v[130:131], v203 offset:1792
  v_mfma_f32_16x16x32_bf16 v[8:11], v[172:175], v[164:167], v[8:11]
  ds_read_b128 v[112:115], v201 offset:0
  v_mfma_f32_16x16x32_bf16 v[12:15], v[172:175], v[168:171], v[12:15]
  ds_read_b128 v[116:119], v201 offset:2048
  v_mfma_f32_16x16x32_bf16 v[16:19], v[176:179], v[156:159], v[16:19]
  ds_read_b128 v[120:123], v201 offset:4096
  v_mfma_f32_16x16x32_bf16 v[20:23], v[176:179], v[160:163], v[20:23]
  ds_read_b128 v[124:127], v201 offset:6144
  v_mfma_f32_16x16x32_bf16 v[24:27], v[176:179], v[164:167], v[24:27]
  ds_read_b64_tr_b16 v[132:133], v204 offset:32
  v_mfma_f32_16x16x32_bf16 v[28:31], v[176:179], v[168:171], v[28:31]
  ds_read_b64_tr_b16 v[134:135], v204 offset:1824
  v_mfma_f32_16x16x32_bf16 v[32:35], v[180:183], v[156:159], v[32:35]
  ds_read_b64_tr_b16 v[136:137], v203 offset:64
  v_mfma_f32_16x16x32_bf16 v[36:39], v[180:183], v[160:163], v[36:39]
  ds_read_b64_tr_b16 v[138:139], v203 offset:1856
  v_mfma_f32_16x16x32_bf16 v[40:43], v[180:183], v[164:167], v[40:43]
  ds_read_b64_tr_b16 v[140:141], v204 offset:96
  v_mfma_f32_16x16x32_bf16 v[44:47], v[180:183], v[168:171], v[44:47]
  ds_read_b64_tr_b16 v[142:143], v204 offset:1888
  v_mfma_f32_16x16x32_bf16 v[48:51], v[184:187], v[156:159], v[48:51]
  ds_read_b64_tr_b16 v[144:145], v203 offset:128
  v_mfma_f32_16x16x32_bf16 v[52:55], v[184:187], v[160:163], v[52:55]
  ds_read_b64_tr_b16 v[146:147], v203 offset:1920
  v_mfma_f32_16x16x32_bf16 v[56:59], v[184:187], v[164:167], v[56:59]
  ds_read_b64_tr_b16 v[148:149], v204 offset:160
  v_mfma_f32_16x16x32_bf16 v[60:63], v[184:187], v[168:171], v[60:63]
  ds_read_b64_tr_b16 v[150:151], v204 offset:1952
  v_mfma_f32_16x16x32_bf16 v[64:67], v[188:191], v[156:159], v[64:67]
  ds_read_b64_tr_b16 v[152:153], v203 offset:192
  v_mfma_f32_16x16x32_bf16 v[68:71], v[188:191], v[160:163], v[68:71]
  ds_read_b64_tr_b16 v[154:155], v203 offset:1984
  v_mfma_f32_16x16x32_bf16 v[72:75], v[188:191], v[164:167], v[72:75]
  v_mfma_f32_16x16x32_bf16 v[76:79], v[188:191], v[168:171], v[76:79]
  v_mfma_f32_16x16x32_bf16 v[80:83], v[192:195], v[156:159], v[80:83]
  v_mfma_f32_16x16x32_bf16 v[84:87], v[192:195], v[160:163], v[84:87]
  v_mfma_f32_16x16x32_bf16 v[88:91], v[192:195], v[164:167], v[88:91]
  v_mfma_f32_16x16x32_bf16 v[92:95], v[192:195], v[168:171], v[92:95]
  v_mfma_f32_16x16x32_bf16 v[96:99], v[196:199], v[156:159], v[96:99]
  v_mfma_f32_16x16x32_bf16 v[100:103], v[196:199], v[160:163], v[100:103]
  v_mfma_f32_16x16x32_bf16 v[104:107], v[196:199], v[164:167], v[104:107]
  v_mfma_f32_16x16x32_bf16 v[108:111], v[196:199], v[168:171], v[108:111]
  s_add_u32 s50, s50, 1
  s_cmp_lt_u32 s50, 15
  s_cbranch_scc1 Lcons_59
  s_waitcnt lgkmcnt(0)
  v_mfma_f32_16x16x32_bf16 v[0:3], v[128:131], v[112:115], v[0:3]
  ds_read_b64_tr_b16 v[172:173], v203 offset:14336
  v_mfma_f32_16x16x32_bf16 v[4:7], v[128:131], v[116:119], v[4:7]
  ds_read_b64_tr_b16 v[174:175], v203 offset:16128
  v_mfma_f32_16x16x32_bf16 v[8:11], v[128:131], v[120:123], v[8:11]
  ds_read_b128 v[156:159], v202 offset:0
  v_mfma_f32_16x16x32_bf16 v[12:15], v[128:131], v[124:127], v[12:15]
  ds_read_b128 v[160:163], v202 offset:2048
  v_mfma_f32_16x16x32_bf16 v[16:19], v[132:135], v[112:115], v[16:19]
  ds_read_b128 v[164:167], v202 offset:4096
  v_mfma_f32_16x16x32_bf16 v[20:23], v[132:135], v[116:119], v[20:23]
  ds_read_b128 v[168:171], v202 offset:6144
  v_mfma_f32_16x16x32_bf16 v[24:27], v[132:135], v[120:123], v[24:27]
  ds_read_b64_tr_b16 v[176:177], v204 offset:14368
  v_mfma_f32_16x16x32_bf16 v[28:31], v[132:135], v[124:127], v[28:31]
  ds_read_b64_tr_b16 v[178:179], v204 offset:16160
  v_mfma_f32_16x16x32_bf16 v[32:35], v[136:139], v[112:115], v[32:35]
  ds_read_b64_tr_b16 v[180:181], v203 offset:14400
  v_mfma_f32_16x16x32_bf16 v[36:39], v[136:139], v[116:119], v[36:39]
  ds_read_b64_tr_b16 v[182:183], v203 offset:16192
  v_mfma_f32_16x16x32_bf16 v[40:43], v[136:139], v[120:123], v[40:43]
  ds_read_b64_tr_b16 v[184:185], v204 offset:14432
  v_mfma_f32_16x16x32_bf16 v[44:47], v[136:139], v[124:127], v[44:47]
  ds_read_b64_tr_b16 v[186:187], v204 offset:16224
  v_mfma_f32_16x16x32_bf16 v[48:51], v[140:143], v[112:115], v[48:51]
  ds_read_b64_tr_b16 v[188:189], v203 offset:14464
  v_mfma_f32_16x16x32_bf16 v[52:55], v[140:143], v[116:119], v[52:55]
  ds_read_b64_tr_b16 v[190:191], v203 offset:16256
  v_mfma_f32_16x16x32_bf16 v[56:59], v[140:143], v[120:123], v[56:59]
  ds_read_b64_tr_b16 v[192:193], v204 offset:14496
  v_mfma_f32_16x16x32_bf16 v[60:63], v[140:143], v[124:127], v[60:63]
  ds_read_b64_tr_b16 v[194:195], v204 offset:16288
  v_mfma_f32_16x16x32_bf16 v[64:67], v[144:147], v[112:115], v[64:67]
  ds_read_b64_tr_b16 v[196:197], v203 offset:14528
  v_mfma_f32_16x16x32_bf16 v[68:71], v[144:147], v[116:119], v[68:71]
  ds_read_b64_tr_b16 v[198:199], v203 offset:16320
  v_mfma_f32_16x16x32_bf16 v[72:75], v[144:147], v[120:123], v[72:75]
  v_mfma_f32_16x16x32_bf16 v[76:79], v[144:147], v[124:127], v[76:79]
  v_mfma_f32_16x16x32_bf16 v[80:83], v[148:151], v[112:115], v[80:83]
  v_mfma_f32_16x16x32_bf16 v[84:87], v[148:151], v[116:119], v[84:87]
  v_mfma_f32_16x16x32_bf16 v[88:91], v[148:151], v[120:123], v[88:91]
  v_mfma_f32_16x16x32_bf16 v[92:95], v[148:151], v[124:127], v[92:95]
  v_mfma_f32_16x16x32_bf16 v[96:99], v[152:155], v[112:115], v[96:99]
  v_mfma_f32_16x16x32_bf16 v[100:103], v[152:155], v[116:119], v[100:103]
  v_mfma_f32_16x16x32_bf16 v[104:107], v[152:155], v[120:123], v[104:107]
  v_mfma_f32_16x16x32_bf16 v[108:111], v[152:155], v[124:127], v[108:111]
  s_waitcnt lgkmcnt(0)
  v_mfma_f32_16x16x32_bf16 v[0:3], v[172:175], v[156:159], v[0:3]
  v_mfma_f32_16x16x32_bf16 v[4:7], v[172:175], v[160:163], v[4:7]
  v_mfma_f32_16x16x32_bf16 v[8:11], v[172:175], v[164:167], v[8:11]
  v_mfma_f32_16x16x32_bf16 v[12:15], v[172:175], v[168:171], v[12:15]
  v_mfma_f32_16x16x32_bf16 v[16:19], v[176:179], v[156:159], v[16:19]
  v_mfma_f32_16x16x32_bf16 v[20:23], v[176:179], v[160:163], v[20:23]
  v_mfma_f32_16x16x32_bf16 v[24:27], v[176:179], v[164:167], v[24:27]
  v_mfma_f32_16x16x32_bf16 v[28:31], v[176:179], v[168:171], v[28:31]
  v_mfma_f32_16x16x32_bf16 v[32:35], v[180:183], v[156:159], v[32:35]
  v_mfma_f32_16x16x32_bf16 v[36:39], v[180:183], v[160:163], v[36:39]
  v_mfma_f32_16x16x32_bf16 v[40:43], v[180:183], v[164:167], v[40:43]
  v_mfma_f32_16x16x32_bf16 v[44:47], v[180:183], v[168:171], v[44:47]
  v_mfma_f32_16x16x32_bf16 v[48:51], v[184:187], v[156:159], v[48:51]
  v_mfma_f32_16x16x32_bf16 v[52:55], v[184:187], v[160:163], v[52:55]
  v_mfma_f32_16x16x32_bf16 v[56:59], v[184:187], v[164:167], v[56:59]
  v_mfma_f32_16x16x32_bf16 v[60:63], v[184:187], v[168:171], v[60:63]
  v_mfma_f32_16x16x32_bf16 v[64:67], v[188:191], v[156:159], v[64:67]
  v_mfma_f32_16x16x32_bf16 v[68:71], v[188:191], v[160:163], v[68:71]
  v_mfma_f32_16x16x32_bf16 v[72:75], v[188:191], v[164:167], v[72:75]
  v_mfma_f32_16x16x32_bf16 v[76:79], v[188:191], v[168:171], v[76:79]
  v_mfma_f32_16x16x32_bf16 v[80:83], v[192:195], v[156:159], v[80:83]
  v_mfma_f32_16x16x32_bf16 v[84:87], v[192:195], v[160:163], v[84:87]
  v_mfma_f32_16x16x32_bf16 v[88:91], v[192:195], v[164:167], v[88:91]
  v_mfma_f32_16x16x32_bf16 v[92:95], v[192:195], v[168:171], v[92:95]
  v_mfma_f32_16x16x32_bf16 v[96:99], v[196:199], v[156:159], v[96:99]
  v_mfma_f32_16x16x32_bf16 v[100:103], v[196:199], v[160:163], v[100:103]
  v_mfma_f32_16x16x32_bf16 v[104:107], v[196:199], v[164:167], v[104:107]
  v_mfma_f32_16x16x32_bf16 v[108:111], v[196:199], v[168:171], v[108:111]
  s_barrier
  s_nop 3
  v_and_b32 v205, 15, v200
  s_mul_i32 s52, s43, 64
  v_add_u32 v205, s52, v205
  v_mul_u32_u24 v206, 464, v205
  v_lshrrev_b32 v207, 4, v200
  v_lshl_add_u32 v206, v207, 3, v206
  s_mul_i32 s52, s44, 224
  s_add_u32 s52, s52, 0
  v_add_u32 v206, s52, v206
  v_lshlrev_b32 v208, 3, v205
  v_add_u32 v208, 151552, v208
  ds_read_b64 v[112:113], v208 offset:0
  ds_read_b64 v[114:115], v208 offset:128
  ds_read_b64 v[116:117], v208 offset:256
  ds_read_b64 v[118:119], v208 offset:384
  v_lshlrev_b32 v209, 4, v207
  s_mul_i32 s52, s44, 448
  v_add_u32 v209, s52, v209
  v_add_u32 v209, 151552, v209
  ds_read_b128 v[120:123], v209 offset:1024
  ds_read_b128 v[124:127], v209 offset:1088
  ds_read_b128 v[128:131], v209 offset:1152
  ds_read_b128 v[132:135], v209 offset:1216
  ds_read_b128 v[136:139], v209 offset:1280
  ds_read_b128 v[140:143], v209 offset:1344
  ds_read_b128 v[144:147], v209 offset:1408
  s_waitcnt lgkmcnt(7)
  v_mov_b32 v148, v113
  v_mov_b32 v150, v115
  v_mov_b32 v152, v117
  v_mov_b32 v154, v119
  s_waitcnt lgkmcnt(6)
  v_pk_fma_f32 v[0:1], v[120:121], v[112:113], v[0:1] op_sel_hi:[1,0,1]
  v_pk_mul_f32 v[0:1], v[0:1], v[148:149] op_sel_hi:[1,0]
  v_pk_fma_f32 v[2:3], v[122:123], v[112:113], v[2:3] op_sel_hi:[1,0,1]
  v_pk_mul_f32 v[2:3], v[2:3], v[148:149] op_sel_hi:[1,0]
  v_cvt_pk_bf16_f32 v0, v0, v1
  v_cvt_pk_bf16_f32 v1, v2, v3
  v_pk_max_i16 v0, v0, 0
  v_pk_max_i16 v1, v1, 0
  ds_write_b64 v206, v[0:1] offset:0
  v_pk_fma_f32 v[4:5], v[120:121], v[114:115], v[4:5] op_sel_hi:[1,0,1]
  v_pk_mul_f32 v[4:5], v[4:5], v[150:151] op_sel_hi:[1,0]
  v_pk_fma_f32 v[6:7], v[122:123], v[114:115], v[6:7] op_sel_hi:[1,0,1]
  v_pk_mul_f32 v[6:7], v[6:7], v[150:151] op_sel_hi:[1,0]
  v_cvt_pk_bf16_f32 v4, v4, v5
  v_cvt_pk_bf16_f32 v5, v6, v7
  v_pk_max_i16 v4, v4, 0
  v_pk_max_i16 v5, v5, 0
  ds_write_b64 v206, v[4:5] offset:7424
  v_pk_fma_f32 v[8:9], v[120:121], v[116:117], v[8:9] op_sel_hi:[1,0,1]
  v_pk_mul_f32 v[8:9], v[8:9], v[152:153] op_sel_hi:[1,0]
  v_pk_fma_f32 v[10:11], v[122:123], v[116:117], v[10:11] op_sel_hi:[1,0,1]
  v_pk_mul_f32 v[10:11], v[10:11], v[152:153] op_sel_hi:[1,0]
  v_cvt_pk_bf16_f32 v8, v8, v9
  v_cvt_pk_bf16_f32 v9, v10, v11
  v_pk_max_i16 v8, v8, 0
  v_pk_max_i16 v9, v9, 0
  ds_write_b64 v206, v[8:9] offset:14848
  v_pk_fma_f32 v[12:13], v[120:121], v[118:119], v[12:13] op_sel_hi:[1,0,1]
  v_pk_mul_f32 v[12:13], v[12:13], v[154:155] op_sel_hi:[1,0]
  v_pk_fma_f32 v[14:15], v[122:123], v[118:119], v[14:15] op_sel_hi:[1,0,1]
  v_pk_mul_f32 v[14:15], v[14:15], v[154:155] op_sel_hi:[1,0]
  v_cvt_pk_bf16_f32 v12, v12, v13
  v_cvt_pk_bf16_f32 v13, v14, v15
  v_pk_max_i16 v12, v12, 0
  v_pk_max_i16 v13, v13, 0
  ds_write_b64 v206, v[12:13] offset:22272
  s_waitcnt lgkmcnt(9)
  v_pk_fma_f32 v[16:17], v[124:125], v[112:113], v[16:17] op_sel_hi:[1,0,1]
  v_pk_mul_f32 v[16:17], v[16:17], v[148:149] op_sel_hi:[1,0]
  v_pk_fma_f32 v[18:19], v[126:127], v[112:113], v[18:19] op_sel_hi:[1,0,1]
  v_pk_mul_f32 v[18:19], v[18:19], v[148:149] op_sel_hi:[1,0]
  v_cvt_pk_bf16_f32 v16, v16, v17
  v_cvt_pk_bf16_f32 v17, v18, v19
  v_pk_max_i16 v16, v16, 0
  v_pk_max_i16 v17, v17, 0
  ds_write_b64 v206, v[16:17] offset:32
  v_pk_fma_f32 v[20:21], v[124:125], v[114:115], v[20:21] op_sel_hi:[1,0,1]
  v_pk_mul_f32 v[20:21], v[20:21], v[150:151] op_sel_hi:[1,0]
  v_pk_fma_f32 v[22:23], v[126:127], v[114:115], v[22:23] op_sel_hi:[1,0,1]
  v_pk_mul_f32 v[22:23], v[22:23], v[150:151] op_sel_hi:[1,0]
  v_cvt_pk_bf16_f32 v20, v20, v21
  v_cvt_pk_bf16_f32 v21, v22, v23
  v_pk_max_i16 v20, v20, 0
  v_pk_max_i16 v21, v21, 0
  ds_write_b64 v206, v[20:21] offset:7456
  v_pk_fma_f32 v[24:25], v[124:125], v[116:117], v[24:25] op_sel_hi:[1,0,1]
  v_pk_mul_f32 v[24:25], v[24:25], v[152:153] op_sel_hi:[1,0]
  v_pk_fma_f32 v[26:27], v[126:127], v[116:117], v[26:27] op_sel_hi:[1,0,1]
  v_pk_mul_f32 v[26:27], v[26:27], v[152:153] op_sel_hi:[1,0]
  v_cvt_pk_bf16_f32 v24, v24, v25
  v_cvt_pk_bf16_f32 v25, v26, v27
  v_pk_max_i16 v24, v24, 0
  v_pk_max_i16 v25, v25, 0
  ds_write_b64 v206, v[24:25] offset:14880
  v_pk_fma_f32 v[28:29], v[124:125], v[118:119], v[28:29] op_sel_hi:[1,0,1]
  v_pk_mul_f32 v[28:29], v[28:29], v[154:155] op_sel_hi:[1,0]
  v_pk_fma_f32 v[30:31], v[126:127], v[118:119], v[30:31] op_sel_hi:[1,0,1]
  v_pk_mul_f32 v[30:31], v[30:31], v[154:155] op_sel_hi:[1,0]
  v_cvt_pk_bf16_f32 v28, v28, v29
  v_cvt_pk_bf16_f32 v29, v30, v31
  v_pk_max_i16 v28, v28, 0
  v_pk_max_i16 v29, v29, 0
  ds_write_b64 v206, v[28:29] offset:22304
  s_waitcnt lgkmcnt(12)
  v_pk_fma_f32 v[32:33], v[128:129], v[112:113], v[32:33] op_sel_hi:[1,0,1]
  v_pk_mul_f32 v[32:33], v[32:33], v[148:149] op_sel_hi:[1,0]
  v_pk_fma_f32 v[34:35], v[130:131], v[112:113], v[34:35] op_sel_hi:[1,0,1]
  v_pk_mul_f32 v[34:35], v[34:35], v[148:149] op_sel_hi:[1,0]
  v_cvt_pk_bf16_f32 v32, v32, v33
  v_cvt_pk_bf16_f32 v33, v34, v35
  v_pk_max_i16 v32, v32, 0
  v_pk_max_i16 v33, v33, 0
  ds_write_b64 v206, v[32:33] offset:64
  v_pk_fma_f32 v[36:37], v[128:129], v[114:115], v[36:37] op_sel_hi:[1,0,1]
  v_pk_mul_f32 v[36:37], v[36:37], v[150:151] op_sel_hi:[1,0]
  v_pk_fma_f32 v[38:39], v[130:131], v[114:115], v[38:39] op_sel_hi:[1,0,1]
  v_pk_mul_f32 v[38:39], v[38:39], v[150:151] op_sel_hi:[1,0]
  v_cvt_pk_bf16_f32 v36, v36, v37
  v_cvt_pk_bf16_f32 v37, v38, v39
  v_pk_max_i16 v36, v36, 0
  v_pk_max_i16 v37, v37, 0
  ds_write_b64 v206, v[36:37] offset:7488
  v_pk_fma_f32 v[40:41], v[128:129], v[116:117], v[40:41] op_sel_hi:[1,0,1]
  v_pk_mul_f32 v[40:41], v[40:41], v[152:153] op_sel_hi:[1,0]
  v_pk_fma_f32 v[42:43], v[130:131], v[116:117], v[42:43] op_sel_hi:[1,0,1]
  v_pk_mul_f32 v[42:43], v[42:43], v[152:153] op_sel_hi:[1,0]
  v_cvt_pk_bf16_f32 v40, v40, v41
  v_cvt_pk_bf16_f32 v41, v42, v43
  v_pk_max_i16 v40, v40, 0
  v_pk_max_i16 v41, v41, 0
  ds_write_b64 v206, v[40:41] offset:14912
  v_pk_fma_f32 v[44:45], v[128:129], v[118:119], v[44:45] op_sel_hi:[1,0,1]
  v_pk_mul_f32 v[44:45], v[44:45], v[154:155] op_sel_hi:[1,0]
  v_pk_fma_f32 v[46:47], v[130:131], v[118:119], v[46:47] op_sel_hi:[1,0,1]
  v_pk_mul_f32 v[46:47], v[46:47], v[154:155] op_sel_hi:[1,0]
  v_cvt_pk_bf16_f32 v44, v44, v45
  v_cvt_pk_bf16_f32 v45, v46, v47
  v_pk_max_i16 v44, v44, 0
  v_pk_max_i16 v45, v45, 0
  ds_write_b64 v206, v[44:45] offset:22336
  s_waitcnt lgkmcnt(15)
  v_pk_fma_f32 v[48:49], v[132:133], v[112:113], v[48:49] op_sel_hi:[1,0,1]
  v_pk_mul_f32 v[48:49], v[48:49], v[148:149] op_sel_hi:[1,0]
  v_pk_fma_f32 v[50:51], v[134:135], v[112:113], v[50:51] op_sel_hi:[1,0,1]
  v_pk_mul_f32 v[50:51], v[50:51], v[148:149] op_sel_hi:[1,0]
  v_cvt_pk_bf16_f32 v48, v48, v49
  v_cvt_pk_bf16_f32 v49, v50, v51
  v_pk_max_i16 v48, v48, 0
  v_pk_max_i16 v49, v49, 0
  ds_write_b64 v206, v[48:49] offset:96
  v_pk_fma_f32 v[52:53], v[132:133], v[114:115], v[52:53] op_sel_hi:[1,0,1]
  v_pk_mul_f32 v[52:53], v[52:53], v[150:151] op_sel_hi:[1,0]
  v_pk_fma_f32 v[54:55], v[134:135], v[114:115], v[54:55] op_sel_hi:[1,0,1]
  v_pk_mul_f32 v[54:55], v[54:55], v[150:151] op_sel_hi:[1,0]
  v_cvt_pk_bf16_f32 v52, v52, v53
  v_cvt_pk_bf16_f32 v53, v54, v55
  v_pk_max_i16 v52, v52, 0
  v_pk_max_i16 v53, v53, 0
  ds_write_b64 v206, v[52:53] offset:7520
  v_pk_fma_f32 v[56:57], v[132:133], v[116:117], v[56:57] op_sel_hi:[1,0,1]
  v_pk_mul_f32 v[56:57], v[56:57], v[152:153] op_sel_hi:[1,0]
  v_pk_fma_f32 v[58:59], v[134:135], v[116:117], v[58:59] op_sel_hi:[1,0,1]
  v_pk_mul_f32 v[58:59], v[58:59], v[152:153] op_sel_hi:[1,0]
  v_cvt_pk_bf16_f32 v56, v56, v57
  v_cvt_pk_bf16_f32 v57, v58, v59
  v_pk_max_i16 v56, v56, 0
  v_pk_max_i16 v57, v57, 0
  ds_write_b64 v206, v[56:57] offset:14944
  v_pk_fma_f32 v[60:61], v[132:133], v[118:119], v[60:61] op_sel_hi:[1,0,1]
  v_pk_mul_f32 v[60:61], v[60:61], v[154:155] op_sel_hi:[1,0]
  v_pk_fma_f32 v[62:63], v[134:135], v[118:119], v[62:63] op_sel_hi:[1,0,1]
  v_pk_mul_f32 v[62:63], v[62:63], v[154:155] op_sel_hi:[1,0]
  v_cvt_pk_bf16_f32 v60, v60, v61
  v_cvt_pk_bf16_f32 v61, v62, v63
  v_pk_max_i16 v60, v60, 0
  v_pk_max_i16 v61, v61, 0
  ds_write_b64 v206, v[60:61] offset:22368
  s_waitcnt lgkmcnt(15)
  v_pk_fma_f32 v[64:65], v[136:137], v[112:113], v[64:65] op_sel_hi:[1,0,1]
  v_pk_mul_f32 v[64:65], v[64:65], v[148:149] op_sel_hi:[1,0]
  v_pk_fma_f32 v[66:67], v[138:139], v[112:113], v[66:67] op_sel_hi:[1,0,1]
  v_pk_mul_f32 v[66:67], v[66:67], v[148:149] op_sel_hi:[1,0]
  v_cvt_pk_bf16_f32 v64, v64, v65
  v_cvt_pk_bf16_f32 v65, v66, v67
  v_pk_max_i16 v64, v64, 0
  v_pk_max_i16 v65, v65, 0
  ds_write_b64 v206, v[64:65] offset:128
  v_pk_fma_f32 v[68:69], v[136:137], v[114:115], v[68:69] op_sel_hi:[1,0,1]
  v_pk_mul_f32 v[68:69], v[68:69], v[150:151] op_sel_hi:[1,0]
  v_pk_fma_f32 v[70:71], v[138:139], v[114:115], v[70:71] op_sel_hi:[1,0,1]
  v_pk_mul_f32 v[70:71], v[70:71], v[150:151] op_sel_hi:[1,0]
  v_cvt_pk_bf16_f32 v68, v68, v69
  v_cvt_pk_bf16_f32 v69, v70, v71
  v_pk_max_i16 v68, v68, 0
  v_pk_max_i16 v69, v69, 0
  ds_write_b64 v206, v[68:69] offset:7552
  v_pk_fma_f32 v[72:73], v[136:137], v[116:117], v[72:73] op_sel_hi:[1,0,1]
  v_pk_mul_f32 v[72:73], v[72:73], v[152:153] op_sel_hi:[1,0]
  v_pk_fma_f32 v[74:75], v[138:139], v[116:117], v[74:75] op_sel_hi:[1,0,1]
  v_pk_mul_f32 v[74:75], v[74:75], v[152:153] op_sel_hi:[1,0]
  v_cvt_pk_bf16_f32 v72, v72, v73
  v_cvt_pk_bf16_f32 v73, v74, v75
  v_pk_max_i16 v72, v72, 0
  v_pk_max_i16 v73, v73, 0
  ds_write_b64 v206, v[72:73] offset:14976
  v_pk_fma_f32 v[76:77], v[136:137], v[118:119], v[76:77] op_sel_hi:[1,0,1]
  v_pk_mul_f32 v[76:77], v[76:77], v[154:155] op_sel_hi:[1,0]
  v_pk_fma_f32 v[78:79], v[138:139], v[118:119], v[78:79] op_sel_hi:[1,0,1]
  v_pk_mul_f32 v[78:79], v[78:79], v[154:155] op_sel_hi:[1,0]
  v_cvt_pk_bf16_f32 v76, v76, v77
  v_cvt_pk_bf16_f32 v77, v78, v79
  v_pk_max_i16 v76, v76, 0
  v_pk_max_i16 v77, v77, 0
  ds_write_b64 v206, v[76:77] offset:22400
  s_waitcnt lgkmcnt(15)
  v_pk_fma_f32 v[80:81], v[140:141], v[112:113], v[80:81] op_sel_hi:[1,0,1]
  v_pk_mul_f32 v[80:81], v[80:81], v[148:149] op_sel_hi:[1,0]
  v_pk_fma_f32 v[82:83], v[142:143], v[112:113], v[82:83] op_sel_hi:[1,0,1]
  v_pk_mul_f32 v[82:83], v[82:83], v[148:149] op_sel_hi:[1,0]
  v_cvt_pk_bf16_f32 v80, v80, v81
  v_cvt_pk_bf16_f32 v81, v82, v83
  v_pk_max_i16 v80, v80, 0
  v_pk_max_i16 v81, v81, 0
  ds_write_b64 v206, v[80:81] offset:160
  v_pk_fma_f32 v[84:85], v[140:141], v[114:115], v[84:85] op_sel_hi:[1,0,1]
  v_pk_mul_f32 v[84:85], v[84:85], v[150:151] op_sel_hi:[1,0]
  v_pk_fma_f32 v[86:87], v[142:143], v[114:115], v[86:87] op_sel_hi:[1,0,1]
  v_pk_mul_f32 v[86:87], v[86:87], v[150:151] op_sel_hi:[1,0]
  v_cvt_pk_bf16_f32 v84, v84, v85
  v_cvt_pk_bf16_f32 v85, v86, v87
  v_pk_max_i16 v84, v84, 0
  v_pk_max_i16 v85, v85, 0
  ds_write_b64 v206, v[84:85] offset:7584
  v_pk_fma_f32 v[88:89], v[140:141], v[116:117], v[88:89] op_sel_hi:[1,0,1]
  v_pk_mul_f32 v[88:89], v[88:89], v[152:153] op_sel_hi:[1,0]
  v_pk_fma_f32 v[90:91], v[142:143], v[116:117], v[90:91] op_sel_hi:[1,0,1]
  v_pk_mul_f32 v[90:91], v[90:91], v[152:153] op_sel_hi:[1,0]
  v_cvt_pk_bf16_f32 v88, v88, v89
  v_cvt_pk_bf16_f32 v89, v90, v91
  v_pk_max_i16 v88, v88, 0
  v_pk_max_i16 v89, v89, 0
  ds_write_b64 v206, v[88:89] offset:15008
  v_pk_fma_f32 v[92:93], v[140:141], v[118:119], v[92:93] op_sel_hi:[1,0,1]
  v_pk_mul_f32 v[92:93], v[92:93], v[154:155] op_sel_hi:[1,0]
  v_pk_fma_f32 v[94:95], v[142:143], v[118:119], v[94:95] op_sel_hi:[1,0,1]
  v_pk_mul_f32 v[94:95], v[94:95], v[154:155] op_sel_hi:[1,0]
  v_cvt_pk_bf16_f32 v92, v92, v93
  v_cvt_pk_bf16_f32 v93, v94, v95
  v_pk_max_i16 v92, v92, 0
  v_pk_max_i16 v93, v93, 0
  ds_write_b64 v206, v[92:93] offset:22432
  s_waitcnt lgkmcnt(15)
  v_pk_fma_f32 v[96:97], v[144:145], v[112:113], v[96:97] op_sel_hi:[1,0,1]
  v_pk_mul_f32 v[96:97], v[96:97], v[148:149] op_sel_hi:[1,0]
  v_pk_fma_f32 v[98:99], v[146:147], v[112:113], v[98:99] op_sel_hi:[1,0,1]
  v_pk_mul_f32 v[98:99], v[98:99], v[148:149] op_sel_hi:[1,0]
  v_cvt_pk_bf16_f32 v96, v96, v97
  v_cvt_pk_bf16_f32 v97, v98, v99
  v_pk_max_i16 v96, v96, 0
  v_pk_max_i16 v97, v97, 0
  ds_write_b64 v206, v[96:97] offset:192
  v_pk_fma_f32 v[100:101], v[144:145], v[114:115], v[100:101] op_sel_hi:[1,0,1]
  v_pk_mul_f32 v[100:101], v[100:101], v[150:151] op_sel_hi:[1,0]
  v_pk_fma_f32 v[102:103], v[146:147], v[114:115], v[102:103] op_sel_hi:[1,0,1]
  v_pk_mul_f32 v[102:103], v[102:103], v[150:151] op_sel_hi:[1,0]
  v_cvt_pk_bf16_f32 v100, v100, v101
  v_cvt_pk_bf16_f32 v101, v102, v103
  v_pk_max_i16 v100, v100, 0
  v_pk_max_i16 v101, v101, 0
  ds_write_b64 v206, v[100:101] offset:7616
  v_pk_fma_f32 v[104:105], v[144:145], v[116:117], v[104:105] op_sel_hi:[1,0,1]
  v_pk_mul_f32 v[104:105], v[104:105], v[152:153] op_sel_hi:[1,0]
  v_pk_fma_f32 v[106:107], v[146:147], v[116:117], v[106:107] op_sel_hi:[1,0,1]
  v_pk_mul_f32 v[106:107], v[106:107], v[152:153] op_sel_hi:[1,0]
  v_cvt_pk_bf16_f32 v104, v104, v105
  v_cvt_pk_bf16_f32 v105, v106, v107
  v_pk_max_i16 v104, v104, 0
  v_pk_max_i16 v105, v105, 0
  ds_write_b64 v206, v[104:105] offset:15040
  v_pk_fma_f32 v[108:109], v[144:145], v[118:119], v[108:109] op_sel_hi:[1,0,1]
  v_pk_mul_f32 v[108:109], v[108:109], v[154:155] op_sel_hi:[1,0]
  v_pk_fma_f32 v[110:111], v[146:147], v[118:119], v[110:111] op_sel_hi:[1,0,1]
  v_pk_mul_f32 v[110:111], v[110:111], v[154:155] op_sel_hi:[1,0]
  v_cvt_pk_bf16_f32 v108, v108, v109
  v_cvt_pk_bf16_f32 v109, v110, v111
  v_pk_max_i16 v108, v108, 0
  v_pk_max_i16 v109, v109, 0
  ds_write_b64 v206, v[108:109] offset:22464
  s_waitcnt lgkmcnt(0)
Lfinal_51:
  s_mul_i32 s52, s40, 448
  v_add_u32 v80, s52, v200
  v_mul_u32_u24 v81, 2341, v80
  v_lshrrev_b32 v81, 16, v81
  v_mul_u32_u24 v82, 28, v81
  v_sub_u32 v82, v80, v82
  v_lshlrev_b32 v82, 4, v82
  v_mul_u32_u24 v83, 464, v81
  v_add_u32 v0, v83, v82
  v_mul_u32_u24 v83, 7296, v81
  v_add_u32 v7, v83, v82
  v_add_u32 v80, s52, v200
  v_add_u32 v80, 64, v80
  v_mul_u32_u24 v81, 2341, v80
  v_lshrrev_b32 v81, 16, v81
  v_mul_u32_u24 v82, 28, v81
  v_sub_u32 v82, v80, v82
  v_lshlrev_b32 v82, 4, v82
  v_mul_u32_u24 v83, 464, v81
  v_add_u32 v1, v83, v82
  v_mul_u32_u24 v83, 7296, v81
  v_add_u32 v8, v83, v82
  v_add_u32 v80, s52, v200
  v_add_u32 v80, 128, v80
  v_mul_u32_u24 v81, 2341, v80
  v_lshrrev_b32 v81, 16, v81
  v_mul_u32_u24 v82, 28, v81
  v_sub_u32 v82, v80, v82
  v_lshlrev_b32 v82, 4, v82
  v_mul_u32_u24 v83, 464, v81
  v_add_u32 v2, v83, v82
  v_mul_u32_u24 v83, 7296, v81
  v_add_u32 v9, v83, v82
  v_add_u32 v80, s52, v200
  v_add_u32 v80, 192, v80
  v_mul_u32_u24 v81, 2341, v80
  v_lshrrev_b32 v81, 16, v81
  v_mul_u32_u24 v82, 28, v81
  v_sub_u32 v82, v80, v82
  v_lshlrev_b32 v82, 4, v82
  v_mul_u32_u24 v83, 464, v81
  v_add_u32 v3, v83, v82
  v_mul_u32_u24 v83, 7296, v81
  v_add_u32 v10, v83, v82
  v_add_u32 v80, s52, v200
  v_add_u32 v80, 256, v80
  v_mul_u32_u24 v81, 2341, v80
  v_lshrrev_b32 v81, 16, v81
  v_mul_u32_u24 v82, 28, v81
  v_sub_u32 v82, v80, v82
  v_lshlrev_b32 v82, 4, v82
  v_mul_u32_u24 v83, 464, v81
  v_add_u32 v4, v83, v82
  v_mul_u32_u24 v83, 7296, v81
  v_add_u32 v11, v83, v82
  v_add_u32 v80, s52, v200
  v_add_u32 v80, 320, v80
  v_mul_u32_u24 v81, 2341, v80
  v_lshrrev_b32 v81, 16, v81
  v_mul_u32_u24 v82, 28, v81
  v_sub_u32 v82, v80, v82
  v_lshlrev_b32 v82, 4, v82
  v_mul_u32_u24 v83, 464, v81
  v_add_u32 v5, v83, v82
  v_mul_u32_u24 v83, 7296, v81
  v_add_u32 v12, v83, v82
  v_add_u32 v80, s52, v200
  v_add_u32 v80, 384, v80
  v_mul_u32_u24 v81, 2341, v80
  v_lshrrev_b32 v81, 16, v81
  v_mul_u32_u24 v82, 28, v81
  v_sub_u32 v82, v80, v82
  v_lshlrev_b32 v82, 4, v82
  v_mul_u32_u24 v83, 464, v81
  v_add_u32 v6, v83, v82
  v_mul_u32_u24 v83, 7296, v81
  v_add_u32 v13, v83, v82
  s_barrier
  ds_read_b128 v[24:27], v0 offset:0
  ds_read_b128 v[28:31], v1 offset:0
  ds_read_b128 v[32:35], v2 offset:0
  ds_read_b128 v[36:39], v3 offset:0
  ds_read_b128 v[40:43], v4 offset:0
  ds_read_b128 v[44:47], v5 offset:0
  ds_read_b128 v[48:51], v6 offset:0
  s_waitcnt lgkmcnt(6)
  buffer_store_dwordx4 v[24:27], v7, s[24:27], 0 offen sc1
  s_waitcnt lgkmcnt(5)
  buffer_store_dwordx4 v[28:31], v8, s[24:27], 0 offen sc1
  s_waitcnt lgkmcnt(4)
  buffer_store_dwordx4 v[32:35], v9, s[24:27], 0 offen sc1
  s_waitcnt lgkmcnt(3)
  buffer_store_dwordx4 v[36:39], v10, s[24:27], 0 offen sc1
  s_waitcnt lgkmcnt(2)
  buffer_store_dwordx4 v[40:43], v11, s[24:27], 0 offen sc1
  s_waitcnt lgkmcnt(1)
  buffer_store_dwordx4 v[44:47], v12, s[24:27], 0 offen sc1
  s_waitcnt lgkmcnt(0)
  buffer_store_dwordx4 v[48:51], v13, s[24:27], 0 offen sc1
LT1_61:
LT1p_58:
  s_waitcnt vmcnt(0)
  s_barrier
  s_cmp_lg_u32 s40, 0
  s_cbranch_scc1 Lflag_62
  s_lshl_b32 s52, s41, 4
  s_add_u32 s52, s52, s42
  s_lshl_b32 s52, s52, 6
  s_add_u32 s52, s52, 33685504
  v_lshlrev_b32 v80, 3, v200
  v_add_u32 v80, s52, v80
  v_mov_b32 v244, s72
  v_mov_b32 v245, s73
  s_mov_b64 s[58:59], exec
  s_mov_b64 exec, 0xff
  global_store_dwordx2 v80, v[244:245], s[4:5] sc1
  s_mov_b64 exec, s[58:59]
Lflag_62:
  v_mbcnt_lo_u32_b32 v96, -1, 0
  v_mbcnt_hi_u32_b32 v96, -1, v96
  s_and_b32 s52, s2, 7
  s_lshr_b32 s53, s2, 3
  s_and_b32 s54, s52, 1
  s_lshr_b32 s55, s52, 1
  s_lshl_b32 s41, s54, 3
  s_and_b32 s54, s53, 7
  s_add_u32 s41, s41, s54
  s_lshl_b32 s42, s55, 2
  s_lshr_b32 s54, s53, 3
  s_add_u32 s42, s42, s54
  s_mul_i32 s52, s41, 933888
  s_add_u32 s52, s52, 10485760
  s_add_u32 s12, s4, s52
  s_addc_u32 s13, s5, 0
  s_mov_b32 s16, s12
  s_and_b32 s17, s13, 0xffff
  s_mov_b32 s18, 0xe4000
  s_mov_b32 s19, 0x00020000
  s_mul_i32 s52, s42, 128
  s_add_u32 s12, s68, s52
  s_addc_u32 s13, s69, 0
  s_sub_u32 s53, 7340032, s52
  s_mov_b32 s20, s12
  s_and_b32 s21, s13, 0xffff
  s_mov_b32 s22, s53
  s_mov_b32 s23, 0x00020000
  s_cmp_lt_u32 s40, 4
  s_cbranch_scc1 Lconsumer_63
  s_sub_u32 s43, s40, 4
  s_mov_b32 s46, 0
  s_mov_b32 s47, 0
  v_lshrrev_b32 v101, 3, v96
  v_and_b32 v102, 7, v96
  s_mul_i32 s52, s43, 32
  v_add_u32 v103, s52, v101
  v_bfe_u32 v104, v103, 1, 3
  v_xor_b32 v104, v104, v102
  v_lshlrev_b32 v104, 4, v104
  s_mov_b32 s53, 7296
  v_mul_lo_u32 v103, v103, s53
  v_add_u32 v32, v103, v104
  v_add_u32 v103, s52, v101
  v_add_u32 v103, 8, v103
  v_bfe_u32 v104, v103, 1, 3
  v_xor_b32 v104, v104, v102
  v_lshlrev_b32 v104, 4, v104
  s_mov_b32 s53, 7296
  v_mul_lo_u32 v103, v103, s53
  v_add_u32 v33, v103, v104
  v_add_u32 v103, s52, v101
  v_add_u32 v103, 16, v103
  v_bfe_u32 v104, v103, 1, 3
  v_xor_b32 v104, v104, v102
  v_lshlrev_b32 v104, 4, v104
  s_mov_b32 s53, 7296
  v_mul_lo_u32 v103, v103, s53
  v_add_u32 v34, v103, v104
  v_add_u32 v103, s52, v101
  v_add_u32 v103, 24, v103
  v_bfe_u32 v104, v103, 1, 3
  v_xor_b32 v104, v104, v102
  v_lshlrev_b32 v104, 4, v104
  s_mov_b32 s53, 7296
  v_mul_lo_u32 v103, v103, s53
  v_add_u32 v35, v103, v104
  s_mul_i32 s52, s43, 128
  v_add_u32 v101, s52, v96
  v_mul_u32_u24 v102, 32, v101
  v_lshrrev_b32 v102, 8, v102
  v_mul_u32_u24 v103, 8, v102
  v_sub_u32 v103, v101, v103
  v_bfe_u32 v104, v102, 1, 1
  v_lshlrev_b32 v104, 1, v104
  v_xor_b32 v103, v103, v104
  v_bfe_u32 v104, v102, 3, 1
  v_lshlrev_b32 v104, 2, v104
  v_xor_b32 v103, v103, v104
  v_lshlrev_b32 v103, 4, v103
  s_mov_b32 s53, 2048
  v_mul_lo_u32 v102, v102, s53
  v_add_u32 v36, v102, v103
  v_add_u32 v101, s52, v96
  v_add_u32 v101, 64, v101
  v_mul_u32_u24 v102, 32, v101
  v_lshrrev_b32 v102, 8, v102
  v_mul_u32_u24 v103, 8, v102
  v_sub_u32 v103, v101, v103
  v_bfe_u32 v104, v102, 1, 1
  v_lshlrev_b32 v104, 1, v104
  v_xor_b32 v103, v103, v104
  v_bfe_u32 v104, v102, 3, 1
  v_lshlrev_b32 v104, 2, v104
  v_xor_b32 v103, v103, v104
  v_lshlrev_b32 v103, 4, v103
  s_mov_b32 s53, 2048
  v_mul_lo_u32 v102, v102, s53
  v_add_u32 v37, v102, v103
  s_mul_i32 s48, s43, 4096
  s_mul_i32 s49, s43, 2048
  s_add_u32 s49, s49, 98304
  s_mov_b32 s45, 0
  s_mov_b32 s51, 0
  s_add_u32 m0, s51, s49
  s_nop 0
  buffer_load_dwordx4 v36, s[20:23], s47 offen lds
  s_add_u32 m0, m0, 0x400
  s_nop 0
  buffer_load_dwordx4 v37, s[20:23], s47 offen lds
  s_add_u32 s51, s51, 8192
  s_cmp_eq_u32 s51, 49152
  s_cselect_b32 s51, 0, s51
  s_add_u32 s47, s47, 131072
  s_add_u32 m0, s51, s49
  s_nop 0
  buffer_load_dwordx4 v36, s[20:23], s47 offen lds
  s_add_u32 m0, m0, 0x400
  s_nop 0
  buffer_load_dwordx4 v37, s[20:23], s47 offen lds
  s_add_u32 s51, s51, 8192
  s_cmp_eq_u32 s51, 49152
  s_cselect_b32 s51, 0, s51
  s_add_u32 s47, s47, 131072
  s_add_u32 m0, s51, s49
  s_nop 0
  buffer_load_dwordx4 v36, s[20:23], s47 offen lds
  s_add_u32 m0, m0, 0x400
  s_nop 0
  buffer_load_dwordx4 v37, s[20:23], s47 offen lds
  s_add_u32 s51, s51, 8192
  s_cmp_eq_u32 s51, 49152
  s_cselect_b32 s51, 0, s51
  s_add_u32 s47, s47, 131072
  s_add_u32 m0, s51, s49
  s_nop 0
  buffer_load_dwordx4 v36, s[20:23], s47 offen lds
  s_add_u32 m0, m0, 0x400
  s_nop 0
  buffer_load_dwordx4 v37, s[20:23], s47 offen lds
  s_add_u32 s51, s51, 8192
  s_cmp_eq_u32 s51, 49152
  s_cselect_b32 s51, 0, s51
  s_add_u32 s47, s47, 131072
  s_add_u32 m0, s51, s49
  s_nop 0
  buffer_load_dwordx4 v36, s[20:23], s47 offen lds
  s_add_u32 m0, m0, 0x400
  s_nop 0
  buffer_load_dwordx4 v37, s[20:23], s47 offen lds
  s_add_u32 s51, s51, 8192
  s_cmp_eq_u32 s51, 49152
  s_cselect_b32 s51, 0, s51
  s_add_u32 s47, s47, 131072
  s_cmp_lg_u32 s40, 4
  s_cbranch_scc1 Lnopoll_65
  s_lshl_b32 s52, s41, 10
  s_add_u32 s52, s52, 33685504
  v_and_b32 v101, 15, v96
  v_lshlrev_b32 v101, 6, v101
  v_add_u32 v101, s52, v101
  v_mov_b32 v56, s72
  v_mov_b32 v57, s73
  s_mov_b32 s57, 0
Lpoll_66:
  global_load_dwordx2 v[58:59], v101, s[4:5] sc1
  s_waitcnt vmcnt(0)
  v_cmp_eq_u64 vcc, v[56:57], v[58:59]
  s_nop 4
  s_cmp_eq_u64 vcc, exec
  s_cbranch_scc1 Lpolld_67
  s_add_u32 s57, s57, 1
  s_cmp_gt_u32 s57, 0x40000
  s_cbranch_scc1 Lpolld_67
  s_sleep 4
  s_branch Lpoll_66
Lpolld_67:
Lnopoll_65:
  s_barrier
  s_add_u32 m0, s45, s48
  s_nop 0
  buffer_load_dwordx4 v32, s[16:19], s46 offen sc1 lds
  s_add_u32 m0, m0, 0x400
  s_nop 0
  buffer_load_dwordx4 v33, s[16:19], s46 offen sc1 lds
  s_add_u32 m0, m0, 0x400
  s_nop 0
  buffer_load_dwordx4 v34, s[16:19], s46 offen sc1 lds
  s_add_u32 m0, m0, 0x400
  s_nop 0
  buffer_load_dwordx4 v35, s[16:19], s46 offen sc1 lds
  s_add_u32 s45, s45, 16384
  s_cmp_eq_u32 s45, 98304
  s_cselect_b32 s45, 0, s45
  s_add_u32 s46, s46, 128
  s_add_u32 m0, s45, s48
  s_nop 0
  buffer_load_dwordx4 v32, s[16:19], s46 offen sc1 lds
  s_add_u32 m0, m0, 0x400
  s_nop 0
  buffer_load_dwordx4 v33, s[16:19], s46 offen sc1 lds
  s_add_u32 m0, m0, 0x400
  s_nop 0
  buffer_load_dwordx4 v34, s[16:19], s46 offen sc1 lds
  s_add_u32 m0, m0, 0x400
  s_nop 0
  buffer_load_dwordx4 v35, s[16:19], s46 offen sc1 lds
  s_add_u32 s45, s45, 16384
  s_cmp_eq_u32 s45, 98304
  s_cselect_b32 s45, 0, s45
  s_add_u32 s46, s46, 128
  s_add_u32 m0, s45, s48
  s_nop 0
  buffer_load_dwordx4 v32, s[16:19], s46 offen sc1 lds
  s_add_u32 m0, m0, 0x400
  s_nop 0
  buffer_load_dwordx4 v33, s[16:19], s46 offen sc1 lds
  s_add_u32 m0, m0, 0x400
  s_nop 0
  buffer_load_dwordx4 v34, s[16:19], s46 offen sc1 lds
  s_add_u32 m0, m0, 0x400
  s_nop 0
  buffer_load_dwordx4 v35, s[16:19], s46 offen sc1 lds
  s_add_u32 s45, s45, 16384
  s_cmp_eq_u32 s45, 98304
  s_cselect_b32 s45, 0, s45
  s_add_u32 s46, s46, 128
  s_add_u32 m0, s45, s48
  s_nop 0
  buffer_load_dwordx4 v32, s[16:19], s46 offen sc1 lds
  s_add_u32 m0, m0, 0x400
  s_nop 0
  buffer_load_dwordx4 v33, s[16:19], s46 offen sc1 lds
  s_add_u32 m0, m0, 0x400
  s_nop 0
  buffer_load_dwordx4 v34, s[16:19], s46 offen sc1 lds
  s_add_u32 m0, m0, 0x400
  s_nop 0
  buffer_load_dwordx4 v35, s[16:19], s46 offen sc1 lds
  s_add_u32 s45, s45, 16384
  s_cmp_eq_u32 s45, 98304
  s_cselect_b32 s45, 0, s45
  s_add_u32 s46, s46, 128
  s_add_u32 m0, s45, s48
  s_nop 0
  buffer_load_dwordx4 v32, s[16:19], s46 offen sc1 lds
  s_add_u32 m0, m0, 0x400
  s_nop 0
  buffer_load_dwordx4 v33, s[16:19], s46 offen sc1 lds
  s_add_u32 m0, m0, 0x400
  s_nop 0
  buffer_load_dwordx4 v34, s[16:19], s46 offen sc1 lds
  s_add_u32 m0, m0, 0x400
  s_nop 0
  buffer_load_dwordx4 v35, s[16:19], s46 offen sc1 lds
  s_add_u32 s45, s45, 16384
  s_cmp_eq_u32 s45, 98304
  s_cselect_b32 s45, 0, s45
  s_add_u32 s46, s46, 128
  s_waitcnt vmcnt(16)
  s_barrier
  s_add_u32 m0, s51, s49
  s_nop 0
  buffer_load_dwordx4 v36, s[20:23], s47 offen lds
  s_add_u32 m0, m0, 0x400
  s_nop 0
  buffer_load_dwordx4 v37, s[20:23], s47 offen lds
  s_add_u32 s51, s51, 8192
  s_cmp_eq_u32 s51, 49152
  s_cselect_b32 s51, 0, s51
  s_add_u32 s47, s47, 131072
  s_add_u32 m0, s45, s48
  s_nop 0
  buffer_load_dwordx4 v32, s[16:19], s46 offen sc1 lds
  s_add_u32 m0, m0, 0x400
  s_nop 0
  buffer_load_dwordx4 v33, s[16:19], s46 offen sc1 lds
  s_add_u32 m0, m0, 0x400
  s_nop 0
  buffer_load_dwordx4 v34, s[16:19], s46 offen sc1 lds
  s_add_u32 m0, m0, 0x400
  s_nop 0
  buffer_load_dwordx4 v35, s[16:19], s46 offen sc1 lds
  s_add_u32 s45, s45, 16384
  s_cmp_eq_u32 s45, 98304
  s_cselect_b32 s45, 0, s45
  s_add_u32 s46, s46, 128
  s_waitcnt vmcnt(18)
  s_barrier
  s_add_u32 m0, s51, s49
  s_nop 0
  buffer_load_dwordx4 v36, s[20:23], s47 offen lds
  s_add_u32 m0, m0, 0x400
  s_nop 0
  buffer_load_dwordx4 v37, s[20:23], s47 offen lds
  s_add_u32 s51, s51, 8192
  s_cmp_eq_u32 s51, 49152
  s_cselect_b32 s51, 0, s51
  s_add_u32 s47, s47, 131072
  s_add_u32 m0, s45, s48
  s_nop 0
  buffer_load_dwordx4 v32, s[16:19], s46 offen sc1 lds
  s_add_u32 m0, m0, 0x400
  s_nop 0
  buffer_load_dwordx4 v33, s[16:19], s46 offen sc1 lds
  s_add_u32 m0, m0, 0x400
  s_nop 0
  buffer_load_dwordx4 v34, s[16:19], s46 offen sc1 lds
  s_add_u32 m0, m0, 0x400
  s_nop 0
  buffer_load_dwordx4 v35, s[16:19], s46 offen sc1 lds
  s_add_u32 s45, s45, 16384
  s_cmp_eq_u32 s45, 98304
  s_cselect_b32 s45, 0, s45
  s_add_u32 s46, s46, 128
  s_waitcnt vmcnt(20)
  s_barrier
  s_add_u32 m0, s51, s49
  s_nop 0
  buffer_load_dwordx4 v36, s[20:23], s47 offen lds
  s_add_u32 m0, m0, 0x400
  s_nop 0
  buffer_load_dwordx4 v37, s[20:23], s47 offen lds
  s_add_u32 s51, s51, 8192
  s_cmp_eq_u32 s51, 49152
  s_cselect_b32 s51, 0, s51
  s_add_u32 s47, s47, 131072
  s_add_u32 m0, s45, s48
  s_nop 0
  buffer_load_dwordx4 v32, s[16:19], s46 offen sc1 lds
  s_add_u32 m0, m0, 0x400
  s_nop 0
  buffer_load_dwordx4 v33, s[16:19], s46 offen sc1 lds
  s_add_u32 m0, m0, 0x400
  s_nop 0
  buffer_load_dwordx4 v34, s[16:19], s46 offen sc1 lds
  s_add_u32 m0, m0, 0x400
  s_nop 0
  buffer_load_dwordx4 v35, s[16:19], s46 offen sc1 lds
  s_add_u32 s45, s45, 16384
  s_cmp_eq_u32 s45, 98304
  s_cselect_b32 s45, 0, s45
  s_add_u32 s46, s46, 128
  s_waitcnt vmcnt(22)
  s_barrier
  s_add_u32 m0, s51, s49
  s_nop 0
  buffer_load_dwordx4 v36, s[20:23], s47 offen lds
  s_add_u32 m0, m0, 0x400
  s_nop 0
  buffer_load_dwordx4 v37, s[20:23], s47 offen lds
  s_add_u32 s51, s51, 8192
  s_cmp_eq_u32 s51, 49152
  s_cselect_b32 s51, 0, s51
  s_add_u32 s47, s47, 131072
  s_add_u32 m0, s45, s48
  s_nop 0
  buffer_load_dwordx4 v32, s[16:19], s46 offen sc1 lds
  s_add_u32 m0, m0, 0x400
  s_nop 0
  buffer_load_dwordx4 v33, s[16:19], s46 offen sc1 lds
  s_add_u32 m0, m0, 0x400
  s_nop 0
  buffer_load_dwordx4 v34, s[16:19], s46 offen sc1 lds
  s_add_u32 m0, m0, 0x400
  s_nop 0
  buffer_load_dwordx4 v35, s[16:19], s46 offen sc1 lds
  s_add_u32 s45, s45, 16384
  s_cmp_eq_u32 s45, 98304
  s_cselect_b32 s45, 0, s45
  s_add_u32 s46, s46, 128
  s_mov_b32 s50, 0
Lprod_68:
  s_waitcnt vmcnt(24)
  s_barrier
  s_add_u32 m0, s51, s49
  s_nop 0
  buffer_load_dwordx4 v36, s[20:23], s47 offen lds
  s_add_u32 m0, m0, 0x400
  s_nop 0
  buffer_load_dwordx4 v37, s[20:23], s47 offen lds
  s_add_u32 s51, s51, 8192
  s_cmp_eq_u32 s51, 49152
  s_cselect_b32 s51, 0, s51
  s_add_u32 s47, s47, 131072
  s_add_u32 m0, s45, s48
  s_nop 0
  buffer_load_dwordx4 v32, s[16:19], s46 offen sc1 lds
  s_add_u32 m0, m0, 0x400
  s_nop 0
  buffer_load_dwordx4 v33, s[16:19], s46 offen sc1 lds
  s_add_u32 m0, m0, 0x400
  s_nop 0
  buffer_load_dwordx4 v34, s[16:19], s46 offen sc1 lds
  s_add_u32 m0, m0, 0x400
  s_nop 0
  buffer_load_dwordx4 v35, s[16:19], s46 offen sc1 lds
  s_add_u32 s45, s45, 16384
  s_cmp_eq_u32 s45, 98304
  s_cselect_b32 s45, 0, s45
  s_add_u32 s46, s46, 128
  s_add_u32 s50, s50, 1
  s_cmp_lt_u32 s50, 47
  s_cbranch_scc1 Lprod_68
  s_waitcnt vmcnt(24)
  s_barrier
  s_waitcnt vmcnt(18)
  s_barrier
  s_waitcnt vmcnt(12)
  s_barrier
  s_waitcnt vmcnt(6)
  s_barrier
  s_waitcnt vmcnt(0)
  s_barrier
  s_mul_i32 s52, s41, 262144
  s_mul_i32 s53, s42, 128
  s_add_u32 s52, s52, s53
  s_add_u32 s12, s8, s52
  s_addc_u32 s13, s9, 0
  s_sub_u32 s53, 4194304, s52
  s_mov_b32 s24, s12
  s_and_b32 s25, s13, 0xffff
  s_mov_b32 s26, s53
  s_mov_b32 s27, 0x00020000
  s_mul_i32 s52, s41, 278528
  s_mul_i32 s53, s42, 128
  s_add_u32 s52, s52, s53
  s_sub_u32 s53, 4456448, s52
  s_add_u32 s54, s52, 5242880
  s_add_u32 s12, s4, s54
  s_addc_u32 s13, s5, 0
  s_mov_b32 s28, s12
  s_and_b32 s29, s13, 0xffff
  s_mov_b32 s30, s53
  s_mov_b32 s31, 0x00020000
  s_barrier
  s_branch Lfinal_64
Lconsumer_63:
  s_lshr_b32 s43, s40, 1
  s_and_b32 s44, s40, 1
  s_mul_i32 s52, s41, 262144
  s_mul_i32 s53, s42, 128
  s_add_u32 s52, s52, s53
  s_add_u32 s12, s8, s52
  s_addc_u32 s13, s9, 0
  s_sub_u32 s53, 4194304, s52
  s_mov_b32 s24, s12
  s_and_b32 s25, s13, 0xffff
  s_mov_b32 s26, s53
  s_mov_b32 s27, 0x00020000
  s_mul_i32 s52, s41, 278528
  s_mul_i32 s53, s42, 128
  s_add_u32 s52, s52, s53
  s_sub_u32 s53, 4456448, s52
  s_add_u32 s54, s52, 5242880
  s_add_u32 s12, s4, s54
  s_addc_u32 s13, s5, 0
  s_mov_b32 s28, s12
  s_and_b32 s29, s13, 0xffff
  s_mov_b32 s30, s53
  s_mov_b32 s31, 0x00020000
  v_and_b32 v101, 15, v96
  v_lshrrev_b32 v102, 4, v96
  v_lshrrev_b32 v103, 1, v101
  s_mul_i32 s52, s43, 64
  v_add_u32 v104, s52, v101
  v_lshlrev_b32 v104, 7, v104
  v_xor_b32 v103, v103, v102
  v_lshl_add_u32 v97, v103, 4, v104
  v_xor_b32 v103, 4, v103
  v_lshl_add_u32 v98, v103, 4, v104
  v_lshrrev_b32 v103, 2, v101
  v_lshl_add_u32 v104, v102, 3, v103
  v_mov_b32 v105, 0
  v_bfe_u32 v106, v104, 1, 1
  v_lshlrev_b32 v106, 0, v106
  v_or_b32 v105, v105, v106
  v_bfe_u32 v106, v104, 3, 1
  v_lshlrev_b32 v106, 1, v106
  v_or_b32 v105, v105, v106
  v_mul_u32_u24 v104, 128, v104
  v_and_b32 v103, 3, v101
  v_lshl_add_u32 v104, v103, 3, v104
  v_add_u32 v104, 98304, v104
  s_mul_i32 s52, s44, 2
  s_add_u32 s53, s52, 0
  v_xor_b32 v103, s53, v105
  v_lshl_add_u32 v99, v103, 5, v104
  s_add_u32 s53, s52, 1
  v_xor_b32 v103, s53, v105
  v_lshl_add_u32 v100, v103, 5, v104
  v_subrev_u32 v100, 32, v100
  s_barrier
  v_mov_b32 v0, 0
  v_mov_b32 v1, 0
  v_mov_b32 v2, 0
  v_mov_b32 v3, 0
  v_mov_b32 v4, 0
  v_mov_b32 v5, 0
  v_mov_b32 v6, 0
  v_mov_b32 v7, 0
  v_mov_b32 v8, 0
  v_mov_b32 v9, 0
  v_mov_b32 v10, 0
  v_mov_b32 v11, 0
  v_mov_b32 v12, 0
  v_mov_b32 v13, 0
  v_mov_b32 v14, 0
  v_mov_b32 v15, 0
  v_mov_b32 v16, 0
  v_mov_b32 v17, 0
  v_mov_b32 v18, 0
  v_mov_b32 v19, 0
  v_mov_b32 v20, 0
  v_mov_b32 v21, 0
  v_mov_b32 v22, 0
  v_mov_b32 v23, 0
  v_mov_b32 v24, 0
  v_mov_b32 v25, 0
  v_mov_b32 v26, 0
  v_mov_b32 v27, 0
  v_mov_b32 v28, 0
  v_mov_b32 v29, 0
  v_mov_b32 v30, 0
  v_mov_b32 v31, 0
  s_mov_b32 s45, 0
  s_mov_b32 s51, 0
  s_barrier
  ds_read_b64_tr_b16 v[48:49], v99 offset:0
  ds_read_b64_tr_b16 v[50:51], v99 offset:512
  ds_read_b128 v[32:35], v97 offset:0
  ds_read_b128 v[36:39], v97 offset:2048
  ds_read_b128 v[40:43], v97 offset:4096
  ds_read_b128 v[44:47], v97 offset:6144
  ds_read_b64_tr_b16 v[52:53], v100 offset:32
  ds_read_b64_tr_b16 v[54:55], v100 offset:544
  s_mov_b32 s50, 0
Lcons_70:
  s_waitcnt lgkmcnt(0)
  v_mfma_f32_16x16x32_bf16 v[0:3], v[48:51], v[32:35], v[0:3]
  ds_read_b64_tr_b16 v[72:73], v99 offset:4096
  ds_read_b64_tr_b16 v[74:75], v99 offset:4608
  v_mfma_f32_16x16x32_bf16 v[4:7], v[48:51], v[36:39], v[4:7]
  ds_read_b128 v[56:59], v98 offset:0
  ds_read_b128 v[60:63], v98 offset:2048
  v_mfma_f32_16x16x32_bf16 v[8:11], v[48:51], v[40:43], v[8:11]
  ds_read_b128 v[64:67], v98 offset:4096
  ds_read_b128 v[68:71], v98 offset:6144
  v_mfma_f32_16x16x32_bf16 v[12:15], v[48:51], v[44:47], v[12:15]
  ds_read_b64_tr_b16 v[76:77], v100 offset:4128
  ds_read_b64_tr_b16 v[78:79], v100 offset:4640
  v_mfma_f32_16x16x32_bf16 v[16:19], v[52:55], v[32:35], v[16:19]
  v_mfma_f32_16x16x32_bf16 v[20:23], v[52:55], v[36:39], v[20:23]
  v_mfma_f32_16x16x32_bf16 v[24:27], v[52:55], v[40:43], v[24:27]
  v_mfma_f32_16x16x32_bf16 v[28:31], v[52:55], v[44:47], v[28:31]
  s_waitcnt lgkmcnt(0)
  s_barrier
  s_add_u32 s45, s45, 16384
  s_mov_b32 s46, 16384
  s_cmp_eq_u32 s45, 98304
  s_cselect_b32 s45, 0, s45
  s_cselect_b32 s46, -81920, s46
  s_add_u32 s51, s51, 8192
  s_mov_b32 s47, 8192
  s_cmp_eq_u32 s51, 49152
  s_cselect_b32 s51, 0, s51
  s_cselect_b32 s47, -40960, s47
  v_add_u32 v97, s46, v97
  v_add_u32 v98, s46, v98
  v_add_u32 v99, s47, v99
  v_add_u32 v100, s47, v100
  v_mfma_f32_16x16x32_bf16 v[0:3], v[72:75], v[56:59], v[0:3]
  ds_read_b64_tr_b16 v[48:49], v99 offset:0
  ds_read_b64_tr_b16 v[50:51], v99 offset:512
  v_mfma_f32_16x16x32_bf16 v[4:7], v[72:75], v[60:63], v[4:7]
  ds_read_b128 v[32:35], v97 offset:0
  ds_read_b128 v[36:39], v97 offset:2048
  v_mfma_f32_16x16x32_bf16 v[8:11], v[72:75], v[64:67], v[8:11]
  ds_read_b128 v[40:43], v97 offset:4096
  ds_read_b128 v[44:47], v97 offset:6144
  v_mfma_f32_16x16x32_bf16 v[12:15], v[72:75], v[68:71], v[12:15]
  ds_read_b64_tr_b16 v[52:53], v100 offset:32
  ds_read_b64_tr_b16 v[54:55], v100 offset:544
  v_mfma_f32_16x16x32_bf16 v[16:19], v[76:79], v[56:59], v[16:19]
  v_mfma_f32_16x16x32_bf16 v[20:23], v[76:79], v[60:63], v[20:23]
  v_mfma_f32_16x16x32_bf16 v[24:27], v[76:79], v[64:67], v[24:27]
  v_mfma_f32_16x16x32_bf16 v[28:31], v[76:79], v[68:71], v[28:31]
  s_add_u32 s50, s50, 1
  s_cmp_lt_u32 s50, 55
  s_cbranch_scc1 Lcons_70
  s_waitcnt lgkmcnt(0)
  v_mfma_f32_16x16x32_bf16 v[0:3], v[48:51], v[32:35], v[0:3]
  ds_read_b64_tr_b16 v[72:73], v99 offset:4096
  ds_read_b64_tr_b16 v[74:75], v99 offset:4608
  v_mfma_f32_16x16x32_bf16 v[4:7], v[48:51], v[36:39], v[4:7]
  ds_read_b128 v[56:59], v98 offset:0
  ds_read_b128 v[60:63], v98 offset:2048
  v_mfma_f32_16x16x32_bf16 v[8:11], v[48:51], v[40:43], v[8:11]
  ds_read_b128 v[64:67], v98 offset:4096
  ds_read_b128 v[68:71], v98 offset:6144
  v_mfma_f32_16x16x32_bf16 v[12:15], v[48:51], v[44:47], v[12:15]
  ds_read_b64_tr_b16 v[76:77], v100 offset:4128
  ds_read_b64_tr_b16 v[78:79], v100 offset:4640
  v_mfma_f32_16x16x32_bf16 v[16:19], v[52:55], v[32:35], v[16:19]
  v_mfma_f32_16x16x32_bf16 v[20:23], v[52:55], v[36:39], v[20:23]
  v_mfma_f32_16x16x32_bf16 v[24:27], v[52:55], v[40:43], v[24:27]
  v_mfma_f32_16x16x32_bf16 v[28:31], v[52:55], v[44:47], v[28:31]
  s_waitcnt lgkmcnt(0)
  v_mfma_f32_16x16x32_bf16 v[0:3], v[72:75], v[56:59], v[0:3]
  v_mfma_f32_16x16x32_bf16 v[4:7], v[72:75], v[60:63], v[4:7]
  v_mfma_f32_16x16x32_bf16 v[8:11], v[72:75], v[64:67], v[8:11]
  v_mfma_f32_16x16x32_bf16 v[12:15], v[72:75], v[68:71], v[12:15]
  v_mfma_f32_16x16x32_bf16 v[16:19], v[76:79], v[56:59], v[16:19]
  v_mfma_f32_16x16x32_bf16 v[20:23], v[76:79], v[60:63], v[20:23]
  v_mfma_f32_16x16x32_bf16 v[24:27], v[76:79], v[64:67], v[24:27]
  v_mfma_f32_16x16x32_bf16 v[28:31], v[76:79], v[68:71], v[28:31]
  s_barrier
  s_nop 3
  v_and_b32 v101, 15, v96
  s_mul_i32 s52, s43, 64
  v_add_u32 v101, s52, v101
  v_mul_u32_u24 v102, 144, v101
  v_lshrrev_b32 v103, 4, v96
  v_lshl_add_u32 v102, v103, 3, v102
  s_mul_i32 s52, s44, 64
  s_add_u32 s52, s52, 0
  v_add_u32 v102, s52, v102
  v_cvt_pk_bf16_f32 v0, v0, v1
  v_cvt_pk_bf16_f32 v1, v2, v3
  ds_write_b64 v102, v[0:1] offset:0
  v_cvt_pk_bf16_f32 v4, v4, v5
  v_cvt_pk_bf16_f32 v5, v6, v7
  ds_write_b64 v102, v[4:5] offset:2304
  v_cvt_pk_bf16_f32 v8, v8, v9
  v_cvt_pk_bf16_f32 v9, v10, v11
  ds_write_b64 v102, v[8:9] offset:4608
  v_cvt_pk_bf16_f32 v12, v12, v13
  v_cvt_pk_bf16_f32 v13, v14, v15
  ds_write_b64 v102, v[12:13] offset:6912
  v_cvt_pk_bf16_f32 v16, v16, v17
  v_cvt_pk_bf16_f32 v17, v18, v19
  ds_write_b64 v102, v[16:17] offset:32
  v_cvt_pk_bf16_f32 v20, v20, v21
  v_cvt_pk_bf16_f32 v21, v22, v23
  ds_write_b64 v102, v[20:21] offset:2336
  v_cvt_pk_bf16_f32 v24, v24, v25
  v_cvt_pk_bf16_f32 v25, v26, v27
  ds_write_b64 v102, v[24:25] offset:4640
  v_cvt_pk_bf16_f32 v28, v28, v29
  v_cvt_pk_bf16_f32 v29, v30, v31
  ds_write_b64 v102, v[28:29] offset:6944
  s_waitcnt lgkmcnt(0)
Lfinal_64:
  s_mul_i32 s52, s40, 128
  v_add_u32 v24, s52, v96
  v_mul_u32_u24 v25, 32, v24
  v_lshrrev_b32 v25, 8, v25
  v_mul_u32_u24 v26, 8, v25
  v_sub_u32 v26, v24, v26
  v_lshlrev_b32 v26, 4, v26
  v_mul_u32_u24 v27, 144, v25
  v_add_u32 v0, v27, v26
  v_mul_u32_u24 v27, 2048, v25
  v_add_u32 v2, v27, v26
  v_mul_u32_u24 v27, 2176, v25
  v_add_u32 v4, v27, v26
  buffer_load_dwordx4 v[16:19], v4, s[28:31], 0 offen sc1
  v_add_u32 v24, s52, v96
  v_add_u32 v24, 64, v24
  v_mul_u32_u24 v25, 32, v24
  v_lshrrev_b32 v25, 8, v25
  v_mul_u32_u24 v26, 8, v25
  v_sub_u32 v26, v24, v26
  v_lshlrev_b32 v26, 4, v26
  v_mul_u32_u24 v27, 144, v25
  v_add_u32 v1, v27, v26
  v_mul_u32_u24 v27, 2048, v25
  v_add_u32 v3, v27, v26
  v_mul_u32_u24 v27, 2176, v25
  v_add_u32 v5, v27, v26
  buffer_load_dwordx4 v[20:23], v5, s[28:31], 0 offen sc1
  s_barrier
  ds_read_b128 v[8:11], v0 offset:0
  ds_read_b128 v[12:15], v1 offset:0
  s_waitcnt vmcnt(0)
  s_waitcnt lgkmcnt(1)
  v_lshlrev_b32 v24, 16, v8
  v_and_b32 v25, 0xffff0000, v8
  v_lshlrev_b32 v26, 16, v16
  v_and_b32 v27, 0xffff0000, v16
  v_add_f32 v24, v24, v26
  v_add_f32 v25, v25, v27
  v_cvt_pk_bf16_f32 v8, v24, v25
  v_lshlrev_b32 v24, 16, v9
  v_and_b32 v25, 0xffff0000, v9
  v_lshlrev_b32 v26, 16, v17
  v_and_b32 v27, 0xffff0000, v17
  v_add_f32 v24, v24, v26
  v_add_f32 v25, v25, v27
  v_cvt_pk_bf16_f32 v9, v24, v25
  v_lshlrev_b32 v24, 16, v10
  v_and_b32 v25, 0xffff0000, v10
  v_lshlrev_b32 v26, 16, v18
  v_and_b32 v27, 0xffff0000, v18
  v_add_f32 v24, v24, v26
  v_add_f32 v25, v25, v27
  v_cvt_pk_bf16_f32 v10, v24, v25
  v_lshlrev_b32 v24, 16, v11
  v_and_b32 v25, 0xffff0000, v11
  v_lshlrev_b32 v26, 16, v19
  v_and_b32 v27, 0xffff0000, v19
  v_add_f32 v24, v24, v26
  v_add_f32 v25, v25, v27
  v_cvt_pk_bf16_f32 v11, v24, v25
  buffer_store_dwordx4 v[8:11], v2, s[24:27], 0 offen
  s_waitcnt lgkmcnt(0)
  v_lshlrev_b32 v24, 16, v12
  v_and_b32 v25, 0xffff0000, v12
  v_lshlrev_b32 v26, 16, v20
  v_and_b32 v27, 0xffff0000, v20
  v_add_f32 v24, v24, v26
  v_add_f32 v25, v25, v27
  v_cvt_pk_bf16_f32 v12, v24, v25
  v_lshlrev_b32 v24, 16, v13
  v_and_b32 v25, 0xffff0000, v13
  v_lshlrev_b32 v26, 16, v21
  v_and_b32 v27, 0xffff0000, v21
  v_add_f32 v24, v24, v26
  v_add_f32 v25, v25, v27
  v_cvt_pk_bf16_f32 v13, v24, v25
  v_lshlrev_b32 v24, 16, v14
  v_and_b32 v25, 0xffff0000, v14
  v_lshlrev_b32 v26, 16, v22
  v_and_b32 v27, 0xffff0000, v22
  v_add_f32 v24, v24, v26
  v_add_f32 v25, v25, v27
  v_cvt_pk_bf16_f32 v14, v24, v25
  v_lshlrev_b32 v24, 16, v15
  v_and_b32 v25, 0xffff0000, v15
  v_lshlrev_b32 v26, 16, v23
  v_and_b32 v27, 0xffff0000, v23
  v_add_f32 v24, v24, v26
  v_add_f32 v25, v25, v27
  v_cvt_pk_bf16_f32 v15, v24, v25
  buffer_store_dwordx4 v[12:15], v3, s[24:27], 0 offen
LT1_71:
LT1p_69:
Lend_1:
  s_endpgm
.section .rodata,"a"
.p2align 6
.amdhsa_kernel mega_kernel
  .amdhsa_next_free_vgpr 256
  .amdhsa_next_free_sgpr 90
  .amdhsa_accum_offset 256
  .amdhsa_group_segment_fixed_size 0
  .amdhsa_kernarg_size 80
  .amdhsa_user_sgpr_count 2
  .amdhsa_user_sgpr_kernarg_segment_ptr 1
  .amdhsa_system_sgpr_workgroup_id_x 1
.end_amdhsa_kernel
```
